```python
import torch

def _softmax(x, axis=-1):
    return torch.softmax(x, dim=axis)
def _gelu(x):
    return torch.nn.functional.gelu(x, approximate="tanh")
def _silu(x):
    return torch.nn.functional.silu(x)
def _sigmoid(x):
    return torch.sigmoid(x)
def _layernorm(x, axis=-1, eps=1e-5):
    m = x.mean(dim=axis, keepdim=True)
    v = x.var(dim=axis, keepdim=True, unbiased=False)
    return (x - m) / torch.sqrt(v + eps)
def _scatter_add(tgt, idx, src, axis=0):
    return tgt.clone().index_add_(axis, idx, src)
def _segment_sum(src, seg, n):
    out = torch.zeros((n,) + src.shape[1:], dtype=src.dtype)
    return out.index_add_(0, seg, src)
def _pad(x, pw):
    flat = tuple(v for pair in reversed(pw) for v in pair)
    return torch.nn.functional.pad(x, flat)

kernel_name = 'interleave_layers__sliding_block_cached__mixer_channel_mlp__decode'

def setup_inputs():

    _w = (lambda a: (lambda t: t.to(torch.bfloat16) if t.is_floating_point() else t)(torch.as_tensor(a)))
    def _A_setup():
        B, Sq, D = 8, 1, 640
        Hq, Hkv, Sk, Dh = 32, 32, 4096, 128
        assert Hq % Hkv == 0, (Hq, Hkv)
        return {
            "x": _w((lambda *s: torch.randn(*s, dtype=torch.bfloat16) * 0.05)(B, Sq, D)),
            "k_cache": _w((lambda *s: torch.randn(*s, dtype=torch.bfloat16) * 3.2)(B, Hkv, Sk, Dh)),
            "v_cache": _w((lambda *s: torch.randn(*s, dtype=torch.bfloat16) * 0.4)(B, Hkv, Sk, Dh)),
            "wq": _w((lambda *s: torch.randn(*s, dtype=torch.bfloat16) * 3.2)(D, Hq * Dh) * (D ** -0.5)),
            "wo": _w((lambda *s: torch.randn(*s, dtype=torch.bfloat16) * 0.4)(Hq * Dh, D) * ((Hq * Dh) ** -0.5)),
        }
    _A_in = _A_setup()

    def _B_setup():
        B, S, D, F = 8, 1, 640, 1728
        return {
            "x": _w((lambda *s: torch.randn(*s, dtype=torch.bfloat16) * 0.05)(B, S, D)),
            "w1": _w((lambda *s: torch.randn(*s, dtype=torch.bfloat16) * 1.6)(D, F) * (D ** -0.5)),
            "b1": _w((lambda *s: torch.randn(*s, dtype=torch.bfloat16) * 1.6)(F)),
            "w2": _w((lambda *s: torch.randn(*s, dtype=torch.bfloat16) * 0.1)(F, D) * (F ** -0.5)),
            "b2": _w((lambda *s: torch.randn(*s, dtype=torch.bfloat16) * 0.1)(D)),
        }
    _B_in = _B_setup()

    return {
        "A_x": _A_in["x"],
        "A_k_cache": _A_in["k_cache"],
        "A_v_cache": _A_in["v_cache"],
        "A_wq": _A_in["wq"],
        "A_wo": _A_in["wo"],
        "B_x": _B_in["x"],
        "B_w1": _B_in["w1"],
        "B_b1": _B_in["b1"],
        "B_w2": _B_in["w2"],
        "B_b2": _B_in["b2"],
    }

def reference(A_x, A_k_cache, A_v_cache, A_wq, A_wo, B_x, B_w1, B_b1, B_w2, B_b2):
    def _A_ref(x, k_cache, v_cache, wq, wo):
        B, Sq, D = x.shape
        Hq, Dh = 32, 128
        Hkv, Sk = k_cache.shape[1], k_cache.shape[2]
        W = min(4096, max(256, Sk // 4))
        rep = Hq // Hkv
        q = (lambda x, *d: x.permute(*d))((x @ wq).reshape(B, Sq, Hq, Dh), 0, 2, 1, 3)
        k = (lambda x, n, axis: torch.repeat_interleave(x, n, dim=axis))(k_cache[:, :, Sk - W:, :], rep, axis=1)
        v = (lambda x, n, axis: torch.repeat_interleave(x, n, dim=axis))(v_cache[:, :, Sk - W:, :], rep, axis=1)
        scores = torch.einsum("bhqd,bhkd->bhqk", q, k) * (Dh ** -0.5)
        p = _softmax(scores, axis=-1)
        o = torch.einsum("bhqk,bhkd->bhqd", p, v)
        return (lambda x, *d: x.permute(*d))(o, 0, 2, 1, 3).reshape(B, Sq, Hq * Dh) @ wo

    def _B_ref(x, w1, b1, w2, b2):
        y = _layernorm(x, axis=-1)
        h = _gelu(torch.einsum("bsd,df->bsf", y, w1) + b1)
        return torch.einsum("bsf,fd->bsd", h, w2) + b2

    x = A_x
    x = x + _A_ref(_layernorm(x, axis=-1), A_k_cache, A_v_cache, A_wq, A_wo)
    x = x + _B_ref(_layernorm(x, axis=-1), B_w1, B_b1, B_w2, B_b2)
    x = x + _A_ref(_layernorm(x, axis=-1), A_k_cache, A_v_cache, A_wq, A_wo)
    x = x + _B_ref(_layernorm(x, axis=-1), B_w1, B_b1, B_w2, B_b2)
    return x
```

```asm
; @launch grid=(256,1,1) block=(256,1,1) lds=163840
.amdgcn_target "amdgcn-amd-amdhsa--gfx950"
.text
.globl interleave_layers__sliding_block_cached__mixer_channel_mlp__decode_kernel
.p2align 8
.type interleave_layers__sliding_block_cached__mixer_channel_mlp__decode_kernel,@function
interleave_layers__sliding_block_cached__mixer_channel_mlp__decode_kernel:
    s_cmp_ge_u32 s2, 256
    s_cbranch_scc1 L_end
    s_load_dwordx16 s[64:79], s[0:1], 0
    s_load_dwordx8 s[80:87], s[0:1], 64
    s_load_dwordx2 s[88:89], s[0:1], 96
    s_getpc_b64 s[94:95]
    v_and_b32 v1, 63, v0
    v_lshrrev_b32 v7, 6, v0
    s_and_b32 s3, s2, 7
    v_readfirstlane_b32 s5, v7
    s_lshr_b32 s4, s2, 3
    s_and_b32 s40, s4, 3
    s_mul_i32 s41, s40, 1
    s_add_u32 s41, s41, s3
    s_and_b32 s41, s41, 7
    s_lshl_b32 s6, s40, 3
    s_add_u32 s6, s6, s41
    s_lshr_b32 s7, s2, 5
    v_lshrrev_b32 v16, 4, v1
    v_and_b32 v17, 15, v1
    v_xor_b32 v18, v17, v16
    v_lshlrev_b32 v124, 8, v16
    v_lshl_add_u32 v124, v18, 4, v124
    v_xor_b32 v125, 64, v124
    v_xor_b32 v126, 128, v124
    v_xor_b32 v127, 192, v124
    s_mul_i32 s34, s5, 36864
    s_add_u32 s34, s34, 16384
    s_lshl_b32 s40, s7, 5
    s_add_u32 s40, s40, s6
    s_lshl_b32 s40, s40, 20
    s_add_u32 s40, s40, 0xC0000
    s_lshl_b32 s32, s5, 12
    s_mov_b32 s33, s32
    s_lshl_b32 s42, s4, 2
    s_add_u32 s42, s42, s5
    s_min_u32 s42, s42, 17
    s_lshl_b32 s42, s42, 10
    v_lshlrev_b32 v19, 4, v1
    v_add_u32 v253, s42, v19
    global_load_dwordx4 v[248:251], v253, s[94:95]
    s_waitcnt lgkmcnt(0)
    s_add_u32 s8, s66, s40
    s_addc_u32 s9, s67, 0
    s_mov_b32 s10, 262144
    s_mov_b32 s11, 0x20000
    s_add_u32 s12, s68, s40
    s_addc_u32 s13, s69, 0
    s_mov_b32 s14, 262144
    s_mov_b32 s15, 0x20000
    s_add_u32 m0, s34, 0
    s_nop 0
    buffer_load_dwordx4 v124, s[8:11], s32 offen offset:0 nt lds
    buffer_load_dwordx4 v125, s[8:11], s32 offen offset:1024 nt lds
    buffer_load_dwordx4 v126, s[8:11], s32 offen offset:2048 nt lds
    buffer_load_dwordx4 v127, s[8:11], s32 offen offset:3072 nt lds
    s_add_u32 s32, s32, 16384
    s_add_u32 m0, s34, 4096
    s_nop 0
    buffer_load_dwordx4 v124, s[8:11], s32 offen offset:0 nt lds
    buffer_load_dwordx4 v125, s[8:11], s32 offen offset:1024 nt lds
    buffer_load_dwordx4 v126, s[8:11], s32 offen offset:2048 nt lds
    buffer_load_dwordx4 v127, s[8:11], s32 offen offset:3072 nt lds
    s_add_u32 s32, s32, 16384
    s_add_u32 m0, s34, 8192
    s_nop 0
    buffer_load_dwordx4 v124, s[8:11], s32 offen offset:0 nt lds
    buffer_load_dwordx4 v125, s[8:11], s32 offen offset:1024 nt lds
    buffer_load_dwordx4 v126, s[8:11], s32 offen offset:2048 nt lds
    buffer_load_dwordx4 v127, s[8:11], s32 offen offset:3072 nt lds
    s_add_u32 s32, s32, 16384
    s_add_u32 m0, s34, 12288
    s_nop 0
    buffer_load_dwordx4 v124, s[8:11], s32 offen offset:0 nt lds
    buffer_load_dwordx4 v125, s[8:11], s32 offen offset:1024 nt lds
    buffer_load_dwordx4 v126, s[8:11], s32 offen offset:2048 nt lds
    buffer_load_dwordx4 v127, s[8:11], s32 offen offset:3072 nt lds
    s_add_u32 s32, s32, 16384
    v_lshlrev_b32 v2, 8, v17
    v_lshl_add_u32 v2, v18, 4, v2
    v_xor_b32 v3, 64, v2
    v_xor_b32 v4, 128, v2
    v_xor_b32 v5, 192, v2
    v_add_u32 v2, s34, v2
    v_add_u32 v3, s34, v3
    v_add_u32 v4, s34, v4
    v_add_u32 v5, s34, v5
    s_getreg_b32 s39, hwreg(HW_REG_XCC_ID)
    s_and_b32 s39, s39, 7
    s_mov_b32 s16, s88
    s_mov_b32 s17, s89
    s_mov_b32 s18, 2752512
    s_mov_b32 s19, 0x20000
    s_mov_b32 s96, s86
    s_mov_b32 s97, s87
    s_mov_b32 s98, 256
    s_mov_b32 s99, 0x20000
    s_mov_b32 s35, 0
    s_mov_b32 s36, 0
    s_mov_b32 s37, 0
    s_mov_b32 s54, 0x3f803f80
    s_mov_b32 s55, 0x00003f80
    s_mov_b32 s56, 0x3f800000
    s_mov_b32 s46, 0xffff0000
    s_mov_b32 s47, 0
    s_mov_b32 s48, 0
    s_mov_b32 s49, 0x0000ffff
    s_mov_b32 s50, 0
    s_mov_b32 s51, 0xffff0000
    s_mov_b32 s52, 0xff00ff00
    s_mov_b32 s53, 0xff00ff00
    s_cmp_eq_u32 s5, 0
    s_cselect_b32 s61, 0, 1073741824
    s_cmp_lt_u32 s5, 2
    s_cselect_b32 s1, 0, 1073741824
    s_add_u32 m0, s34, 16384
    s_nop 0
    buffer_load_dwordx4 v124, s[8:11], s32 offen offset:0 nt lds
    s_mov_b32 s24, s78
    s_mov_b32 s25, s79
    s_mov_b32 s26, 3456
    s_mov_b32 s27, 0x20000
    s_sub_u32 s40, s4, 10
    s_cmp_lt_u32 s4, 10
    s_cselect_b32 s78, s4, s40
    s_cselect_b32 s41, 0, 1
    s_sub_u32 s40, s4, 20
    s_cmp_ge_u32 s4, 20
    s_cselect_b32 s78, s40, s78
    s_lshl_b32 s40, s78, 5
    s_lshl_b32 s42, s3, 1
    s_add_u32 s40, s40, s42
    s_add_u32 s40, s40, s41
    s_lshl_b32 s40, s40, 10
    s_add_u32 s40, s40, 589824
    s_lshl_b32 s41, s78, 4
    s_add_u32 s41, s41, s3
    s_lshl_b32 s41, s41, 10
    s_add_u32 s41, s41, 917504
    s_cmp_lt_u32 s4, 20
    s_cselect_b32 s79, s40, s41
    s_cmp_ge_u32 s4, 30
    s_cmov_b32 s79, 1073741824
    buffer_load_dwordx4 v125, s[8:11], s32 offen offset:1024 nt lds
    v_mov_b32 v56, -1
    v_mov_b32 v57, -1
    v_mov_b32 v58, -1
    v_mov_b32 v59, -1
    v_lshrrev_b32 v41, 4, v1
    v_and_b32 v42, 15, v1
    s_and_b32 s41, s7, 3
    s_lshl_b32 s41, s41, 3
    s_lshr_b32 s40, s7, 2
    s_lshl_b32 s40, s40, 2
    s_add_u32 s41, s41, s40
    s_add_u32 s41, s41, s5
    s_lshl_b32 s40, s6, 5
    s_add_u32 s41, s41, s40
    s_lshl_b32 s40, s41, 9
    v_lshlrev_b32 v40, 6, v42
    v_add_u32 v40, s40, v40
    s_lshl_b32 s40, s41, 6
    s_add_u32 s40, s40, 1310720
    v_cmp_eq_u32 vcc, 8, v42
    v_mov_b32 v42, s40
    s_mov_b32 s42, 0xfe00fe00
    s_mov_b32 s43, 0xfe00fe00
    v_cndmask_b32 v40, v40, v42, vcc
    v_lshl_add_u32 v40, v41, 4, v40
    v_mov_b32 v41, 2147418112
    v_cndmask_b32 v40, v40, v41, s[42:43]
    buffer_store_dwordx4 v[56:59], v40, s[16:19], s35 offen
    buffer_load_dwordx4 v126, s[8:11], s32 offen offset:2048 nt lds
    s_lshl_b32 s40, s6, 11
    s_lshl_b32 s41, s7, 8
    s_add_u32 s40, s40, s41
    s_add_u32 s40, s40, s61
    s_add_u32 s40, s40, 524288
    v_lshlrev_b32 v43, 2, v1
    v_add_u32 v43, s40, v43
    buffer_store_dword v56, v43, s[16:19], s35 offen
    buffer_load_dwordx4 v127, s[8:11], s32 offen offset:3072 nt lds
    s_add_u32 s32, s32, 16384
    s_mul_i32 s40, s3, 640
    s_mul_i32 s41, s78, 32
    s_add_u32 s40, s40, s41
    s_mul_i32 s41, s5, 16
    s_add_u32 s40, s40, s41
    s_add_u32 s40, s40, s1
    s_add_u32 s40, s40, 1277952
    s_mov_b32 s41, 0
    s_cmp_ge_u32 s4, 10
    s_cmov_b32 s41, 4
    s_cmp_ge_u32 s4, 20
    s_cmov_b32 s41, 320
    s_cmp_ge_u32 s4, 30
    s_cmov_b32 s41, 1073741824
    s_add_u32 s40, s40, s41
    v_lshlrev_b32 v44, 24, v1
    v_add_u32 v44, s40, v44
    buffer_store_dword v56, v44, s[16:19], s35 offen
    s_waitcnt vmcnt(19)
    ds_read_b128 a[0:3], v2 offset:0
    ds_read_b128 a[4:7], v3 offset:0
    ds_read_b128 a[8:11], v4 offset:0
    ds_read_b128 a[12:15], v5 offset:0
    s_waitcnt lgkmcnt(0)
    s_mul_i32 s40, s3, 10240
    s_lshl_b32 s41, s4, 9
    s_add_u32 s40, s40, s41
    s_add_u32 s40, s40, s61
    s_add_u32 s40, s40, 1081344
    v_and_b32 v46, 0x38, v1
    v_and_b32 v41, 7, v1
    v_lshl_add_u32 v46, v41, 6, v46
    v_add_u32 v46, s40, v46
    s_cmp_lt_u32 s4, 20
    s_cselect_b32 s40, 0, 1073741824
    v_add_u32 v46, s40, v46
    buffer_store_dwordx2 v[56:57], v46, s[16:19], s35 offen
    s_add_u32 m0, s34, 20480
    s_nop 0
    buffer_load_dwordx4 v124, s[8:11], s32 offen offset:0 nt lds
    v_add_u32 v45, 81920, v46
    buffer_store_dwordx2 v[56:57], v45, s[16:19], s35 offen
    buffer_load_dwordx4 v125, s[8:11], s32 offen offset:1024 nt lds
    v_lshrrev_b32 v41, 4, v1
    v_and_b32 v42, 15, v1
    s_sub_u32 s41, s4, 20
    s_cmp_eq_u32 s4, 31
    s_cmov_b32 s41, 12
    s_add_u32 s41, s41, s5
    s_lshl_b32 s40, s3, 12
    s_lshl_b32 s41, s41, 8
    s_add_u32 s40, s40, s41
    s_cmp_ge_u32 s4, 30
    s_cselect_b32 s41, s1, s61
    s_add_u32 s40, s40, s41
    s_add_u32 s40, s40, 1245184
    v_lshlrev_b32 v47, 3, v41
    v_and_b32 v41, 7, v42
    v_lshl_add_u32 v47, v41, 5, v47
    v_lshrrev_b32 v41, 3, v42
    v_lshl_add_u32 v47, v41, 2, v47
    v_add_u32 v47, s40, v47
    s_lshl_b32 s41, s4, 2
    s_add_u32 s41, s41, s5
    s_mov_b32 s44, 0
    s_cmp_eq_u32 s41, 125
    s_cselect_b32 s45, -1, 0
    v_mov_b32 v41, 2147418112
    v_cndmask_b32 v47, v47, v41, s[44:45]
    s_cmp_ge_u32 s4, 20
    s_cselect_b32 s40, 0, 1073741824
    v_or_b32 v47, s40, v47
    buffer_store_dword v56, v47, s[16:19], s35 offen
    buffer_load_dwordx4 v126, s[8:11], s32 offen offset:2048 nt lds
    v_lshrrev_b32 v41, 4, v1
    v_and_b32 v42, 15, v1
    s_cmp_lt_u32 s4, 20
    s_cselect_b32 s41, 14, 13
    s_lshl_b32 s40, s5, s41
    s_add_u32 s40, s40, s79
    s_add_u32 s40, s40, s1
    v_lshlrev_b32 v44, 7, v41
    v_and_b32 v41, 7, v42
    v_lshl_add_u32 v44, v41, 4, v44
    v_lshrrev_b32 v41, 3, v42
    v_lshl_add_u32 v44, v41, 9, v44
    v_add_u32 v44, s40, v44
    buffer_store_dwordx4 v[56:59], v44, s[16:19], s35 offen sc1
    buffer_load_dwordx4 v127, s[8:11], s32 offen offset:3072 nt lds
    s_add_u32 s32, s32, 16384
    v_lshrrev_b32 v16, 4, v1
    v_and_b32 v17, 15, v1
    v_lshlrev_b32 v18, 1, v16
    v_xor_b32 v19, v17, v18
    v_lshlrev_b32 v6, 8, v16
    v_lshl_add_u32 v6, v19, 4, v6
    v_xor_b32 v7, 0x80, v6
    v_lshrrev_b32 v26, 5, v0
    v_mul_u32_u24 v27, 1280, v26
    v_and_b32 v26, 31, v0
    v_lshl_add_u32 v27, v26, 3, v27
    v_lshrrev_b32 v28, 3, v1
    v_and_b32 v29, 7, v1
    v_lshlrev_b32 v30, 13, v28
    v_lshl_add_u32 v30, v29, 4, v30
    v_lshrrev_b32 v28, 3, v17
    v_and_b32 v33, 0x38, v1
    s_lshl_b32 s40, s4, 6
    v_add_u32 v33, s40, v33
    v_and_b32 v29, 7, v1
    v_mul_u32_u24 v34, 1280, v29
    v_add_u32 v60, v34, v33
    v_mov_b32 v61, v33
    s_waitcnt vmcnt(23)
    ds_read_b128 a[16:19], v2 offset:4096
    ds_read_b128 a[20:23], v3 offset:4096
    ds_read_b128 a[24:27], v4 offset:4096
    ds_read_b128 a[28:31], v5 offset:4096
    s_waitcnt lgkmcnt(0)
    s_sub_u32 s43, s4, 20
    s_cmp_eq_u32 s4, 31
    s_cmov_b32 s43, 12
    s_mul_i32 s42, s3, 432
    s_lshl_b32 s43, s43, 5
    s_add_u32 s42, s42, s43
    s_cmp_lt_u32 s4, 20
    s_cselect_b32 s0, 2147418112, s42
    s_and_b32 s43, s5, 1
    s_lshl_b32 s43, s43, 5
    s_add_u32 s43, s43, s0
    v_lshlrev_b32 v35, 3, v16
    v_lshl_add_u32 v35, v28, 2, v35
    v_add_u32 v35, s43, v35
    buffer_load_dword v66, v35, s[24:27], 0 offen
    v_lshrrev_b32 v28, 2, v1
    v_lshlrev_b32 v8, 8, v28
    v_and_b32 v29, 7, v28
    v_lshl_add_u32 v8, v29, 5, v8
    v_and_b32 v29, 3, v1
    v_lshl_add_u32 v8, v29, 3, v8
    v_xor_b32 v9, 32, v8
    v_xor_b32 v10, 64, v8
    v_xor_b32 v11, 96, v8
    v_xor_b32 v12, 128, v8
    v_xor_b32 v13, 160, v8
    v_xor_b32 v14, 192, v8
    v_xor_b32 v15, 224, v8
    v_add_u32 v8, s34, v8
    v_add_u32 v9, s34, v9
    v_add_u32 v10, s34, v10
    v_add_u32 v11, s34, v11
    v_add_u32 v12, s34, v12
    v_add_u32 v13, s34, v13
    v_add_u32 v14, s34, v14
    v_add_u32 v15, s34, v15
    s_add_u32 m0, s34, 24576
    s_nop 0
    buffer_load_dwordx4 v124, s[8:11], s32 offen offset:0 nt lds
    v_bfe_u32 v28, v1, 2, 2
    v_lshlrev_b32 v28, 7, v28
    v_lshl_add_u32 v28, v29, 3, v28
    s_lshl_b32 s40, s5, 5
    v_add_u32 v28, s40, v28
    v_mul_u32_u24 v254, 36864, v16
    v_add_u32 v254, v254, v28
    v_add_u32 v254, 49152, v254
    v_lshl_add_u32 v255, v16, 10, v28
    s_mov_b32 s24, s70
    s_mov_b32 s25, s71
    s_mov_b32 s26, 5242880
    s_mov_b32 s27, 0x20000
    s_and_b32 s40, s7, 3
    s_mul_i32 s40, s40, 160
    s_lshl_b32 s41, s5, 3
    s_add_u32 s40, s40, s41
    s_lshl_b32 s40, s40, 13
    s_lshl_b32 s41, s6, 8
    s_add_u32 s40, s40, s41
    s_lshr_b32 s41, s7, 2
    s_lshl_b32 s41, s41, 7
    s_add_u32 s59, s40, s41
    s_lshl_b32 s60, s5, 10
    s_add_u32 m0, s34, 32768
    s_nop 0
    buffer_load_dwordx4 v30, s[24:27], s59 offen nt lds
    s_add_u32 s59, s59, 262144
    s_add_u32 m0, s34, 33792
    s_nop 0
    buffer_load_dwordx4 v30, s[24:27], s59 offen nt lds
    s_add_u32 s59, s59, 262144
    s_add_u32 m0, s34, 24576
    s_nop 0
    buffer_load_dwordx4 v125, s[8:11], s32 offen offset:1024 nt lds
    s_add_u32 m0, s34, 34816
    s_nop 0
    buffer_load_dwordx4 v30, s[24:27], s59 offen nt lds
    s_add_u32 s59, s59, 262144
    s_add_u32 m0, s34, 35840
    s_nop 0
    buffer_load_dwordx4 v30, s[24:27], s59 offen nt lds
    s_add_u32 s59, s59, 262144
    s_add_u32 m0, s34, 24576
    s_nop 0
    buffer_load_dwordx4 v126, s[8:11], s32 offen offset:2048 nt lds
    s_add_u32 m0, s60, 10368
    s_nop 0
    buffer_load_dwordx4 v30, s[24:27], s59 offen nt lds
    s_add_u32 s59, s59, 262144
    s_mov_b32 s20, s64
    s_mov_b32 s21, s65
    s_mov_b32 s22, 10240
    s_mov_b32 s23, 0x20000
    v_mul_u32_u24 v27, 1280, v17
    v_lshl_add_u32 v27, v16, 4, v27
    v_cmp_eq_u32 vcc, 8, v17
    v_mov_b32 v26, 0x3f803f80
    s_and_b32 s41, s7, 3
    s_mul_i32 s41, s41, 320
    v_cndmask_b32 v26, 0, v26, vcc
    v_lshlrev_b32 v36, 4, v1
    v_add_u32 v37, 1024, v36
    v_mov_b32 v38, 2147418112
    v_cmp_le_u32 vcc, 16, v1
    s_mul_i32 s40, s7, 1280
    v_mov_b32 v28, v27
    v_cndmask_b32 v37, v37, v38, vcc
    v_mov_b32 v38, v26
    v_mov_b32 v39, v28
    v_mov_b32 v16, v38
    v_mov_b32 v17, v38
    v_mov_b32 v18, v38
    v_mov_b32 v19, v38
    v_mov_b32 v20, v38
    v_mov_b32 v21, v38
    v_mov_b32 v22, v38
    v_mov_b32 v23, v38
    v_mov_b32 v24, v38
    v_mov_b32 v25, v38
    v_mov_b32 v26, v38
    v_mov_b32 v27, v38
    v_mov_b32 v28, v38
    v_mov_b32 v29, v38
    v_mov_b32 v30, v38
    v_mov_b32 v31, v38
    v_mov_b32 v32, v38
    v_mov_b32 v33, v38
    v_mov_b32 v34, v38
    v_mov_b32 v35, v38
    s_not_b64 exec, s[52:53]
    buffer_load_dwordx4 v[16:19], v39, s[20:23], s41 offen offset:0
    buffer_load_dwordx4 v[20:23], v39, s[20:23], s41 offen offset:64
    buffer_load_dwordx4 v[24:27], v39, s[20:23], s41 offen offset:128
    buffer_load_dwordx4 v[28:31], v39, s[20:23], s41 offen offset:192
    buffer_load_dwordx4 v[32:35], v39, s[20:23], s41 offen offset:256
    s_mov_b64 exec, -1
    buffer_load_dwordx4 v[48:51], v36, s[20:23], s40 offen
    buffer_load_dwordx4 v[52:55], v37, s[20:23], s40 offen
    buffer_load_dwordx2 v[62:63], v60, s[20:23], 0 offen
    s_add_u32 m0, s34, 24576
    s_nop 0
    buffer_load_dwordx4 v127, s[8:11], s32 offen offset:3072 nt lds
    s_add_u32 s32, s32, 16384
    s_mov_b32 s20, s82
    s_mov_b32 s21, s83
    s_mov_b32 s22, 1280
    s_mov_b32 s23, 0x20000
    buffer_load_dwordx2 v[64:65], v61, s[20:23], 0 offen
    s_mov_b32 s24, s84
    s_mov_b32 s25, s85
    s_mov_b32 s26, 10240
    s_mov_b32 s27, 0x20000
    buffer_load_dword v67, v61, s[24:27], 0 offen
    s_waitcnt vmcnt(39)
    ds_read_b128 a[32:35], v2 offset:8192
    ds_read_b128 a[36:39], v3 offset:8192
    ds_read_b128 a[40:43], v4 offset:8192
    ds_read_b128 a[44:47], v5 offset:8192
    s_waitcnt lgkmcnt(0)
    s_add_u32 m0, s34, 28672
    s_nop 0
    buffer_load_dwordx4 v124, s[8:11], s32 offen offset:0 nt lds
    buffer_load_dwordx4 v125, s[8:11], s32 offen offset:1024 nt lds
    buffer_load_dwordx4 v126, s[8:11], s32 offen offset:2048 nt lds
    buffer_load_dwordx4 v127, s[8:11], s32 offen offset:3072 nt lds
    s_add_u32 s32, s32, 16384
    s_waitcnt vmcnt(39)
    ds_read_b128 a[48:51], v2 offset:12288
    ds_read_b128 a[52:55], v3 offset:12288
    ds_read_b128 a[56:59], v4 offset:12288
    ds_read_b128 a[60:63], v5 offset:12288
    s_waitcnt lgkmcnt(0)
    s_add_u32 m0, s34, 0
    s_nop 0
    buffer_load_dwordx4 v124, s[8:11], s32 offen offset:0 nt lds
    buffer_load_dwordx4 v125, s[8:11], s32 offen offset:1024 nt lds
    buffer_load_dwordx4 v126, s[8:11], s32 offen offset:2048 nt lds
    s_waitcnt vmcnt(7)
    v_lshlrev_b32 v39, 3, v1
    ds_write_b64 v39, v[62:63] offset:14592
    ds_write_b64 v39, v[64:65] offset:15104
    s_and_b32 s40, s5, 1
    s_lshl_b32 s40, s40, 8
    v_lshlrev_b32 v39, 2, v1
    v_add_u32 v39, s40, v39
    ds_write_b32 v39, v66 offset:15616
    v_and_b32 v39, 31, v1
    v_lshlrev_b32 v39, 2, v39
    v_mov_b32 v38, 0
    ds_write_b32 v39, v38 offset:16128
    s_barrier
    ds_read_b64_tr_b16 v[72:73], v254 offset:0
    ds_read_b64_tr_b16 v[74:75], v254 offset:512
    ds_read_b64_tr_b16 v[76:77], v254 offset:1024
    ds_read_b64_tr_b16 v[78:79], v254 offset:1536
    ds_read_b64_tr_b16 v[80:81], v254 offset:2048
    ds_read_b64_tr_b16 v[82:83], v254 offset:2560
    ds_read_b64_tr_b16 v[84:85], v254 offset:3072
    ds_read_b64_tr_b16 v[86:87], v254 offset:3584
    ds_read_b64_tr_b16 v[88:89], v255 offset:10368
    ds_read_b64_tr_b16 v[90:91], v255 offset:10880
    s_add_u32 s40, s39, 1
    s_and_b32 s41, s4, 3
    s_lshl_b32 s41, s41, 3
    s_lshl_b32 s40, s40, s41
    v_mov_b32 v66, s40
    s_lshl_b32 s40, s3, 5
    s_add_u32 s40, s40, s4
    s_and_b32 s40, s40, 0xfc
    v_lshlrev_b32 v39, 8, v0
    v_add_u32 v39, s40, v39
    buffer_atomic_or v66, v39, s[96:99], 0 offen sc1
    v_lshrrev_b32 v40, 4, v1
    v_and_b32 v41, 15, v1
    s_and_b32 s41, s7, 3
    s_lshl_b32 s41, s41, 3
    s_lshr_b32 s40, s7, 2
    s_lshl_b32 s40, s40, 2
    s_add_u32 s41, s41, s40
    s_add_u32 s41, s41, s5
    s_lshl_b32 s40, s6, 5
    s_add_u32 s41, s41, s40
    s_lshl_b32 s40, s41, 9
    v_lshlrev_b32 v45, 6, v41
    v_add_u32 v45, s40, v45
    s_lshl_b32 s40, s41, 6
    s_add_u32 s40, s40, 1310720
    v_cmp_eq_u32 vcc, 8, v41
    v_mov_b32 v41, s40
    s_mov_b32 s42, 0xfe00fe00
    s_mov_b32 s43, 0xfe00fe00
    v_cndmask_b32 v45, v45, v41, vcc
    v_lshl_add_u32 v45, v40, 4, v45
    v_mov_b32 v40, 2147418112
    v_cndmask_b32 v45, v45, v40, s[42:43]
    buffer_load_dwordx4 v127, s[8:11], s32 offen offset:3072 nt lds
    s_add_u32 s32, s32, 16384
    s_waitcnt vmcnt(38)
    ds_read_b128 a[64:67], v2 offset:16384
    ds_read_b128 a[68:71], v3 offset:16384
    ds_read_b128 a[72:75], v4 offset:16384
    ds_read_b128 a[76:79], v5 offset:16384
    s_waitcnt lgkmcnt(0)
    v_dot2_f32_bf16 v43, v48, s54, 0
    v_dot2_f32_bf16 v44, v48, v48, 0
    v_dot2_f32_bf16 v43, v49, s54, v43
    v_dot2_f32_bf16 v44, v49, v49, v44
    v_dot2_f32_bf16 v43, v50, s54, v43
    v_dot2_f32_bf16 v44, v50, v50, v44
    v_dot2_f32_bf16 v43, v51, s54, v43
    v_dot2_f32_bf16 v44, v51, v51, v44
    v_dot2_f32_bf16 v43, v52, s54, v43
    v_dot2_f32_bf16 v44, v52, v52, v44
    v_dot2_f32_bf16 v43, v53, s54, v43
    v_dot2_f32_bf16 v44, v53, v53, v44
    v_dot2_f32_bf16 v43, v54, s54, v43
    v_dot2_f32_bf16 v44, v54, v54, v44
    v_dot2_f32_bf16 v43, v55, s54, v43
    v_dot2_f32_bf16 v44, v55, v55, v44
    s_nop 2
    v_add_f32_dpp v43, v43, v43 quad_perm:[1,0,3,2] row_mask:0xf bank_mask:0xf
    v_add_f32_dpp v44, v44, v44 quad_perm:[1,0,3,2] row_mask:0xf bank_mask:0xf
    s_nop 0
    v_add_f32_dpp v43, v43, v43 quad_perm:[2,3,0,1] row_mask:0xf bank_mask:0xf
    v_add_f32_dpp v44, v44, v44 quad_perm:[2,3,0,1] row_mask:0xf bank_mask:0xf
    s_nop 0
    v_add_f32_dpp v43, v43, v43 row_half_mirror row_mask:0xf bank_mask:0xf
    v_add_f32_dpp v44, v44, v44 row_half_mirror row_mask:0xf bank_mask:0xf
    s_nop 0
    v_add_f32_dpp v43, v43, v43 row_mirror row_mask:0xf bank_mask:0xf
    v_add_f32_dpp v44, v44, v44 row_mirror row_mask:0xf bank_mask:0xf
    s_nop 0
    v_mov_b32 v48, v43
    v_mov_b32 v49, v44
    s_nop 0
    v_permlane16_swap_b32 v43, v48
    v_permlane16_swap_b32 v44, v49
    s_nop 0
    v_add_f32 v43, v43, v48
    v_add_f32 v44, v44, v49
    v_mov_b32 v48, v43
    v_mov_b32 v49, v44
    s_nop 0
    v_permlane32_swap_b32 v43, v48
    v_permlane32_swap_b32 v44, v49
    s_nop 0
    v_add_f32 v43, v43, v48
    v_add_f32 v44, v44, v49
    v_mul_f32 v48, 0x3acccccd, v43
    v_mul_f32 v44, 0x3acccccd, v44
    v_fma_f32 v44, -v48, v48, v44
    v_max_f32 v44, 0, v44
    v_add_f32 v44, 0x3727c5ac, v44
    v_rsq_f32 v43, v44
    s_nop 0
    v_mul_f32 v44, -v48, v43
    s_add_u32 m0, s34, 4096
    s_nop 0
    buffer_load_dwordx4 v124, s[8:11], s32 offen offset:0 nt lds
    buffer_load_dwordx4 v125, s[8:11], s32 offen offset:1024 nt lds
    s_waitcnt lgkmcnt(0)
    v_mfma_f32_16x16x32_bf16 v[68:71], v[72:75], v[16:19], 0
    v_mfma_f32_16x16x32_bf16 v[68:71], v[76:79], v[20:23], v[68:71]
    v_mfma_f32_16x16x32_bf16 v[68:71], v[80:83], v[24:27], v[68:71]
    v_mfma_f32_16x16x32_bf16 v[68:71], v[84:87], v[28:31], v[68:71]
    v_mfma_f32_16x16x32_bf16 v[68:71], v[88:91], v[32:35], v[68:71]
    s_nop 7
    v_min_u32 v68, -2, v68
    v_min_u32 v69, -2, v69
    v_min_u32 v70, -2, v70
    v_min_u32 v71, -2, v71
    buffer_load_dwordx4 v126, s[8:11], s32 offen offset:2048 nt lds
    buffer_load_dwordx4 v127, s[8:11], s32 offen offset:3072 nt lds
    s_add_u32 s32, s32, 16384
    s_waitcnt vmcnt(33)
    ds_read_b128 a[80:83], v2 offset:20480
    ds_read_b128 a[84:87], v3 offset:20480
    ds_read_b128 a[88:91], v4 offset:20480
    ds_read_b128 a[92:95], v5 offset:20480
    s_waitcnt lgkmcnt(0)
    v_lshlrev_b32 v40, 2, v1
    s_lshl_b32 s40, s6, 14
    s_lshl_b32 s41, s7, 6
    s_add_u32 s40, s40, s41
    v_lshrrev_b32 v41, 3, v1
    v_lshlrev_b32 v41, 9, v41
    v_add_u32 v41, s40, v41
    v_and_b32 v42, 7, v1
    v_lshl_add_u32 v41, v42, 3, v41
    s_add_u32 s82, s35, 0
    s_add_u32 s83, s35, 4096
    s_add_u32 s86, s35, 8192
    s_add_u32 s87, s35, 12288
    s_add_u32 m0, s34, 8192
    s_nop 0
    buffer_load_dwordx4 v124, s[8:11], s32 offen offset:0 nt lds
    buffer_load_dwordx4 v125, s[8:11], s32 offen offset:1024 nt lds
    buffer_load_dwordx4 v126, s[8:11], s32 offen offset:2048 nt lds
    buffer_load_dwordx4 v127, s[8:11], s32 offen offset:3072 nt lds
    s_add_u32 s32, s32, 16384
    s_waitcnt vmcnt(19)
    ds_read_b128 a[96:99], v2 offset:24576
    ds_read_b128 a[100:103], v3 offset:24576
    ds_read_b128 a[104:107], v4 offset:24576
    ds_read_b128 a[108:111], v5 offset:24576
    s_waitcnt lgkmcnt(0)
    s_add_u32 m0, s34, 12288
    s_nop 0
    buffer_load_dwordx4 v124, s[8:11], s32 offen offset:0 nt lds
    s_waitcnt vmcnt(5)
    buffer_load_dwordx4 v125, s[8:11], s32 offen offset:1024 nt lds
    s_waitcnt vmcnt(5)
    buffer_load_dwordx4 v126, s[8:11], s32 offen offset:2048 nt lds
    s_waitcnt vmcnt(5)
    buffer_load_dwordx4 v127, s[8:11], s32 offen offset:3072 nt lds
    s_waitcnt vmcnt(5)
    s_add_u32 s32, s32, 16384
    s_waitcnt vmcnt(17)
    ds_read_b128 a[112:115], v2 offset:28672
    ds_read_b128 a[116:119], v3 offset:28672
    ds_read_b128 a[120:123], v4 offset:28672
    ds_read_b128 a[124:127], v5 offset:28672
    s_waitcnt lgkmcnt(0)
    s_waitcnt vmcnt(12)
    ds_read_b128 a[128:131], v2 offset:0
    ds_read_b128 a[132:135], v3 offset:0
    ds_read_b128 a[136:139], v4 offset:0
    ds_read_b128 a[140:143], v5 offset:0
    s_waitcnt lgkmcnt(0)
    s_add_u32 m0, s34, 16384
    s_nop 0
    buffer_load_dwordx4 v124, s[8:11], s32 offen offset:0 nt lds
    s_waitcnt vmcnt(5)
    buffer_load_dwordx4 v125, s[8:11], s32 offen offset:1024 nt lds
    s_waitcnt vmcnt(5)
    buffer_load_dwordx4 v126, s[8:11], s32 offen offset:2048 nt lds
    s_waitcnt vmcnt(5)
    buffer_load_dwordx4 v127, s[8:11], s32 offen offset:3072 nt lds
    s_waitcnt vmcnt(5)
    s_add_u32 s32, s32, 16384
    s_waitcnt vmcnt(12)
    ds_read_b128 a[144:147], v2 offset:4096
    ds_read_b128 a[148:151], v3 offset:4096
    ds_read_b128 a[152:155], v4 offset:4096
    ds_read_b128 a[156:159], v5 offset:4096
    s_waitcnt lgkmcnt(0)
    s_waitcnt vmcnt(8)
    ds_read_b128 a[160:163], v2 offset:8192
    ds_read_b128 a[164:167], v3 offset:8192
    ds_read_b128 a[168:171], v4 offset:8192
    ds_read_b128 a[172:175], v5 offset:8192
    s_waitcnt lgkmcnt(0)
    s_add_u32 m0, s34, 20480
    s_nop 0
    buffer_load_dwordx4 v124, s[8:11], s32 offen offset:0 nt lds
    s_waitcnt vmcnt(5)
    buffer_load_dwordx4 v125, s[8:11], s32 offen offset:1024 nt lds
    s_waitcnt vmcnt(5)
    buffer_load_dwordx4 v126, s[8:11], s32 offen offset:2048 nt lds
    s_waitcnt vmcnt(5)
    buffer_load_dwordx4 v127, s[8:11], s32 offen offset:3072 nt lds
    s_waitcnt vmcnt(5)
    s_add_u32 s32, s32, 16384
    s_waitcnt vmcnt(8)
    ds_read_b128 a[176:179], v2 offset:12288
    ds_read_b128 a[180:183], v3 offset:12288
    ds_read_b128 a[184:187], v4 offset:12288
    ds_read_b128 a[188:191], v5 offset:12288
    s_waitcnt lgkmcnt(0)
    buffer_load_dword v36, v40, s[96:99], 0 offen sc1
    s_add_u32 m0, s34, 24576
    s_nop 0
    buffer_load_dwordx4 v124, s[8:11], s32 offen offset:0 nt lds
    s_waitcnt vmcnt(5)
    buffer_load_dwordx4 v125, s[8:11], s32 offen offset:1024 nt lds
    s_waitcnt vmcnt(5)
    buffer_load_dwordx4 v126, s[8:11], s32 offen offset:2048 nt lds
    s_waitcnt vmcnt(5)
    buffer_load_dwordx4 v127, s[8:11], s32 offen offset:3072 nt lds
    s_waitcnt vmcnt(5)
    s_add_u32 s32, s32, 16384
    s_waitcnt vmcnt(9)
    ds_read_b128 a[192:195], v2 offset:16384
    ds_read_b128 a[196:199], v3 offset:16384
    ds_read_b128 a[200:203], v4 offset:16384
    ds_read_b128 a[204:207], v5 offset:16384
    s_waitcnt lgkmcnt(0)
    s_add_u32 m0, s34, 28672
    s_nop 0
    buffer_load_dwordx4 v124, s[8:11], s32 offen offset:0 nt lds
    s_waitcnt vmcnt(5)
    buffer_load_dwordx4 v125, s[8:11], s32 offen offset:1024 nt lds
    s_waitcnt vmcnt(5)
    buffer_load_dwordx4 v126, s[8:11], s32 offen offset:2048 nt lds
    s_waitcnt vmcnt(5)
    buffer_load_dwordx4 v127, s[8:11], s32 offen offset:3072 nt lds
    s_waitcnt vmcnt(5)
    s_add_u32 s32, s32, 16384
    s_waitcnt vmcnt(9)
    ds_read_b128 a[208:211], v2 offset:20480
    ds_read_b128 a[212:215], v3 offset:20480
    ds_read_b128 a[216:219], v4 offset:20480
    ds_read_b128 a[220:223], v5 offset:20480
    s_waitcnt lgkmcnt(0)
    s_waitcnt vmcnt(8)
    v_and_b32 v38, 0x40404040, v36
    v_and_b32 v36, 0x3f3f3f3f, v36
    v_subrev_u32 v37, 0x01010101, v36
    v_bfi_b32 v37, v36, 0, v37
    v_and_b32 v37, 0x80808080, v37
    s_add_u32 s40, s39, 1
    s_mul_i32 s40, s40, 0x01010101
    v_cmp_ne_u32 vcc, 0, v37
    v_cmp_eq_u32 s[42:43], s40, v36
    s_lshl_b32 s41, s3, 3
    s_nop 0
    s_cmp_eq_u64 vcc, 0
    s_cselect_b32 s57, 1, 0
    s_lshr_b64 s[42:43], s[42:43], s41
    s_and_b32 s42, s42, 0xff
    s_cmp_eq_u32 s42, 0xff
    s_cselect_b32 s37, 1, 0
    s_cmp_eq_u32 s37, 1
    s_cbranch_scc1 Lpl_1
    buffer_store_dwordx4 v[68:71], v45, s[16:19], s35 offen sc1
    s_branch Lpe_2
Lpl_1:
    buffer_store_dwordx4 v[68:71], v45, s[16:19], s35 offen
Lpe_2:
    s_add_u32 m0, s34, 0
    s_nop 0
    buffer_load_dwordx4 v6, s[12:15], s33 offen offset:0 nt lds
    s_waitcnt vmcnt(5)
    buffer_load_dwordx4 v7, s[12:15], s33 offen offset:1024 nt lds
    s_waitcnt vmcnt(5)
    buffer_load_dwordx4 v6, s[12:15], s33 offen offset:2048 nt lds
    s_waitcnt vmcnt(5)
    buffer_load_dwordx4 v7, s[12:15], s33 offen offset:3072 nt lds
    s_waitcnt vmcnt(5)
    s_add_u32 s33, s33, 16384
    s_add_u32 m0, s34, 4096
    s_nop 0
    buffer_load_dwordx4 v6, s[12:15], s33 offen offset:0 nt lds
    s_waitcnt vmcnt(5)
    buffer_load_dwordx4 v7, s[12:15], s33 offen offset:1024 nt lds
    s_waitcnt vmcnt(5)
    buffer_load_dwordx4 v6, s[12:15], s33 offen offset:2048 nt lds
    s_waitcnt vmcnt(5)
    buffer_load_dwordx4 v7, s[12:15], s33 offen offset:3072 nt lds
    s_waitcnt vmcnt(5)
    s_add_u32 s33, s33, 16384
    s_waitcnt vmcnt(13)
    ds_read_b128 a[224:227], v2 offset:24576
    ds_read_b128 a[228:231], v3 offset:24576
    ds_read_b128 a[232:235], v4 offset:24576
    ds_read_b128 a[236:239], v5 offset:24576
    s_waitcnt lgkmcnt(0)
    s_waitcnt vmcnt(9)
    ds_read_b128 v[124:127], v2 offset:28672
    ds_read_b128 v[128:131], v3 offset:28672
    ds_read_b128 v[132:135], v4 offset:28672
    ds_read_b128 v[136:139], v5 offset:28672
    s_waitcnt lgkmcnt(0)
    s_add_u32 m0, s34, 8192
    s_nop 0
    buffer_load_dwordx4 v6, s[12:15], s33 offen offset:0 nt lds
    s_waitcnt vmcnt(5)
    buffer_load_dwordx4 v7, s[12:15], s33 offen offset:1024 nt lds
    s_waitcnt vmcnt(5)
    buffer_load_dwordx4 v6, s[12:15], s33 offen offset:2048 nt lds
    s_waitcnt vmcnt(5)
    buffer_load_dwordx4 v7, s[12:15], s33 offen offset:3072 nt lds
    s_waitcnt vmcnt(5)
    s_add_u32 s33, s33, 16384
    s_waitcnt vmcnt(8)
    ds_read_b64_tr_b16 v[144:145], v8 offset:0
    ds_read_b64_tr_b16 v[152:153], v9 offset:0
    ds_read_b64_tr_b16 v[160:161], v10 offset:0
    ds_read_b64_tr_b16 v[168:169], v11 offset:0
    ds_read_b64_tr_b16 v[176:177], v12 offset:0
    ds_read_b64_tr_b16 v[184:185], v13 offset:0
    ds_read_b64_tr_b16 v[192:193], v14 offset:0
    ds_read_b64_tr_b16 v[200:201], v15 offset:0
    s_waitcnt lgkmcnt(0)
    s_add_u32 m0, s34, 12288
    s_nop 0
    buffer_load_dwordx4 v6, s[12:15], s33 offen offset:0 nt lds
    s_waitcnt vmcnt(5)
    buffer_load_dwordx4 v7, s[12:15], s33 offen offset:1024 nt lds
    s_waitcnt vmcnt(5)
    buffer_load_dwordx4 v6, s[12:15], s33 offen offset:2048 nt lds
    s_waitcnt vmcnt(5)
    buffer_load_dwordx4 v7, s[12:15], s33 offen offset:3072 nt lds
    s_waitcnt vmcnt(5)
    s_add_u32 s33, s33, 16384
    s_lshl_b32 s59, s6, 11
    s_add_u32 s59, s59, 1310720
    v_lshlrev_b32 v40, 3, v1
    buffer_load_dwordx2 v[16:17], v41, s[16:19], s82 offen offset:0 sc1
    buffer_load_dwordx2 v[18:19], v41, s[16:19], s83 offen offset:0 sc1
    buffer_load_dwordx2 v[20:21], v41, s[16:19], s86 offen offset:0 sc1
    buffer_load_dwordx2 v[22:23], v41, s[16:19], s87 offen offset:0 sc1
    buffer_load_dwordx2 v[32:33], v40, s[16:19], s59 offen offset:0 sc1
    buffer_load_dwordx2 v[34:35], v40, s[16:19], s59 offen offset:512 sc1
    buffer_load_dwordx2 v[36:37], v40, s[16:19], s59 offen offset:1024 sc1
    buffer_load_dwordx2 v[38:39], v40, s[16:19], s59 offen offset:1536 sc1
    v_lshlrev_b32 v40, 2, v1
    global_load_dwordx4 v[248:251], v253, s[94:95]
    s_waitcnt vmcnt(17)
    ds_read_b64_tr_b16 v[146:147], v8 offset:4096
    ds_read_b64_tr_b16 v[154:155], v9 offset:4096
    ds_read_b64_tr_b16 v[162:163], v10 offset:4096
    ds_read_b64_tr_b16 v[170:171], v11 offset:4096
    ds_read_b64_tr_b16 v[178:179], v12 offset:4096
    ds_read_b64_tr_b16 v[186:187], v13 offset:4096
    ds_read_b64_tr_b16 v[194:195], v14 offset:4096
    ds_read_b64_tr_b16 v[202:203], v15 offset:4096
    s_waitcnt lgkmcnt(0)
    s_add_u32 m0, s34, 16384
    s_nop 0
    buffer_load_dwordx4 v6, s[12:15], s33 offen offset:0 nt lds
    s_waitcnt vmcnt(15)
    buffer_load_dwordx4 v7, s[12:15], s33 offen offset:1024 nt lds
    s_waitcnt vmcnt(16)
    buffer_load_dwordx4 v6, s[12:15], s33 offen offset:2048 nt lds
    s_waitcnt vmcnt(17)
    buffer_load_dwordx4 v7, s[12:15], s33 offen offset:3072 nt lds
    s_waitcnt vmcnt(18)
    s_add_u32 s33, s33, 16384
    s_waitcnt vmcnt(17)
    ds_read_b64_tr_b16 v[148:149], v8 offset:8192
    ds_read_b64_tr_b16 v[156:157], v9 offset:8192
    ds_read_b64_tr_b16 v[164:165], v10 offset:8192
    ds_read_b64_tr_b16 v[172:173], v11 offset:8192
    ds_read_b64_tr_b16 v[180:181], v12 offset:8192
    ds_read_b64_tr_b16 v[188:189], v13 offset:8192
    ds_read_b64_tr_b16 v[196:197], v14 offset:8192
    ds_read_b64_tr_b16 v[204:205], v15 offset:8192
    s_waitcnt lgkmcnt(0)
    s_add_u32 m0, s34, 20480
    s_nop 0
    buffer_load_dwordx4 v6, s[12:15], s33 offen offset:0 nt lds
    s_waitcnt vmcnt(19)
    buffer_load_dwordx4 v7, s[12:15], s33 offen offset:1024 nt lds
    s_waitcnt vmcnt(20)
    buffer_load_dwordx4 v6, s[12:15], s33 offen offset:2048 nt lds
    s_waitcnt vmcnt(21)
    buffer_load_dwordx4 v7, s[12:15], s33 offen offset:3072 nt lds
    s_waitcnt vmcnt(22)
    s_add_u32 s33, s33, 16384
    s_add_u32 m0, s34, 24576
    s_nop 0
    buffer_load_dwordx4 v6, s[12:15], s33 offen offset:0 nt lds
    s_waitcnt vmcnt(23)
    buffer_load_dwordx4 v7, s[12:15], s33 offen offset:1024 nt lds
    s_waitcnt vmcnt(24)
    buffer_load_dwordx4 v6, s[12:15], s33 offen offset:2048 nt lds
    s_waitcnt vmcnt(5)
    buffer_load_dwordx4 v7, s[12:15], s33 offen offset:3072 nt lds
    s_waitcnt vmcnt(5)
    s_add_u32 s33, s33, 16384
    s_lshl_b32 s40, s5, 8
    s_add_u32 s40, s40, 10368
    s_lshl_b32 s41, s5, 9
    v_and_b32 v24, 1, v1
    v_lshrrev_b32 v25, 1, v1
    v_lshlrev_b32 v4, 7, v24
    v_lshl_add_u32 v4, v25, 2, v4
    v_add_u32 v4, s40, v4
    v_mul_u32_u24 v5, 0xaaaa, v24
    v_add_u32 v5, 0x4444, v5
    v_lshrrev_b32 v25, 4, v1
    v_lshlrev_b32 v26, 7, v24
    v_lshl_add_u32 v26, v25, 4, v26
    v_add_u32 v26, s40, v26
    v_mov_b32 v27, 16128
    s_mov_b32 s44, 0x000f000f
    s_mov_b32 s45, 0x000f000f
    v_cndmask_b32 v65, v27, v26, s[44:45]
    s_lshl_b64 s[44:45], s[44:45], 4
    v_cndmask_b32 v66, v27, v26, s[44:45]
    s_lshl_b64 s[44:45], s[44:45], 4
    v_cndmask_b32 v67, v27, v26, s[44:45]
    s_lshl_b64 s[44:45], s[44:45], 4
    v_cndmask_b32 v68, v27, v26, s[44:45]
    v_lshlrev_b32 v2, 5, v25
    v_lshl_add_u32 v2, v24, 4, v2
    v_add_u32 v2, s41, v2
    v_lshlrev_b32 v3, 4, v25
    v_add_u32 v3, s41, v3
    v_mov_b32 v27, 15744
    v_cmp_eq_u32 vcc, 1, v24
    v_bfe_u32 v28, v1, 3, 1
    v_lshlrev_b32 v29, 5, v28
    v_cndmask_b32 v3, v3, v27, vcc
    v_bfe_u32 v28, v1, 1, 1
    v_lshl_add_u32 v29, v28, 4, v29
    v_bfe_u32 v28, v1, 2, 1
    v_lshl_add_u32 v29, v28, 3, v29
    v_bfe_u32 v28, v1, 4, 1
    v_lshl_add_u32 v29, v28, 2, v29
    v_lshl_add_u32 v29, v24, 1, v29
    v_add_u32 v29, s41, v29
    v_bfe_u32 v30, v1, 2, 2
    v_lshlrev_b32 v30, 4, v30
    v_lshl_add_u32 v30, v28, 3, v30
    v_and_b32 v31, 3, v1
    v_lshl_add_u32 v30, v31, 1, v30
    v_add_u32 v30, s41, v30
    v_add_u32 v31, 64, v29
    s_mov_b32 vcc_lo, 0
    s_mov_b32 vcc_hi, -1
    v_cndmask_b32 v69, v29, v31, vcc
    v_add_u32 v31, 256, v29
    v_add_u32 v28, 384, v30
    v_cndmask_b32 v70, v28, v31, vcc
    v_add_u32 v31, 320, v29
    v_add_u32 v28, 448, v30
    v_cndmask_b32 v71, v31, v28, vcc
    v_mov_b32 v48, 0
    v_mov_b32 v49, 0
    v_mov_b32 v52, 0
    v_mov_b32 v53, 0
    v_mov_b32 v56, 0
    v_mov_b32 v57, 0
    v_mov_b32 v60, 0
    v_mov_b32 v61, 0
    s_waitcnt vmcnt(13)
    v_max3_u32 v42, v16, v17, v18
    v_max3_u32 v42, v42, v19, v20
    v_max3_u32 v42, v42, v21, v22
    v_max3_u32 v42, v42, v23, v32
    v_max3_u32 v42, v42, v33, v34
    v_max3_u32 v42, v42, v35, v36
    v_max3_u32 v42, v42, v37, v38
    v_max_u32 v42, v42, v39
    v_cmp_eq_u32 vcc, -1, v42
    s_and_b32 s40, s57, s37
    s_cmp_eq_u32 s40, 0
    s_cbranch_scc1 L_slow
    s_cbranch_vccz L_att0
L_slow:
    s_mov_b32 s38, 0
L_slowf:
    buffer_load_dword v24, v40, s[96:99], 0 offen sc1
    s_add_u32 s38, s38, 1
    s_cmp_gt_u32 s38, 100000
    s_cbranch_scc1 L_abort
    s_waitcnt vmcnt(0)
    v_and_b32 v26, 0x40404040, v24
    v_and_b32 v24, 0x3f3f3f3f, v24
    v_subrev_u32 v25, 0x01010101, v24
    v_bfi_b32 v25, v24, 0, v25
    v_and_b32 v25, 0x80808080, v25
    s_add_u32 s40, s39, 1
    s_mul_i32 s40, s40, 0x01010101
    v_cmp_ne_u32 vcc, 0, v25
    v_cmp_eq_u32 s[42:43], s40, v24
    s_lshl_b32 s41, s3, 3
    s_nop 0
    s_cmp_eq_u64 vcc, 0
    s_cselect_b32 s57, 1, 0
    s_lshr_b64 s[42:43], s[42:43], s41
    s_and_b32 s42, s42, 0xff
    s_cmp_eq_u32 s42, 0xff
    s_cselect_b32 s37, 1, 0
    s_cmp_eq_u32 s57, 0
    s_cbranch_scc1 L_slowf
    s_cmp_eq_u32 s37, 1
    s_cbranch_scc1 L_slowq
    v_mov_b32 v28, v43
    v_mov_b32 v29, v44
    v_mov_b32 v24, -1
    v_mov_b32 v25, -1
    v_mov_b32 v26, -1
    v_mov_b32 v27, -1
    s_lshl_b32 s40, s6, 11
    s_lshl_b32 s41, s7, 8
    s_add_u32 s40, s40, s41
    s_add_u32 s40, s40, s61
    s_add_u32 s40, s40, 524288
    v_lshlrev_b32 v43, 2, v1
    v_add_u32 v43, s40, v43
    buffer_store_dword v24, v43, s[16:19], s35 offen sc1
    s_mul_i32 s40, s3, 640
    s_mul_i32 s41, s78, 32
    s_add_u32 s40, s40, s41
    s_mul_i32 s41, s5, 16
    s_add_u32 s40, s40, s41
    s_add_u32 s40, s40, s1
    s_add_u32 s40, s40, 1277952
    s_mov_b32 s41, 0
    s_cmp_ge_u32 s4, 10
    s_cmov_b32 s41, 4
    s_cmp_ge_u32 s4, 20
    s_cmov_b32 s41, 320
    s_cmp_ge_u32 s4, 30
    s_cmov_b32 s41, 1073741824
    s_add_u32 s40, s40, s41
    v_lshlrev_b32 v44, 24, v1
    v_add_u32 v44, s40, v44
    buffer_store_dword v24, v44, s[16:19], s35 offen sc1
    s_mul_i32 s40, s3, 10240
    s_lshl_b32 s41, s4, 9
    s_add_u32 s40, s40, s41
    s_add_u32 s40, s40, s61
    s_add_u32 s40, s40, 1081344
    v_and_b32 v46, 0x38, v1
    v_and_b32 v41, 7, v1
    v_lshl_add_u32 v46, v41, 6, v46
    v_add_u32 v46, s40, v46
    s_cmp_lt_u32 s4, 20
    s_cselect_b32 s40, 0, 1073741824
    v_add_u32 v46, s40, v46
    buffer_store_dwordx2 v[24:25], v46, s[16:19], s35 offen sc1
    v_add_u32 v45, 81920, v46
    buffer_store_dwordx2 v[24:25], v45, s[16:19], s35 offen sc1
    v_lshrrev_b32 v41, 4, v1
    v_and_b32 v42, 15, v1
    s_sub_u32 s41, s4, 20
    s_cmp_eq_u32 s4, 31
    s_cmov_b32 s41, 12
    s_add_u32 s41, s41, s5
    s_lshl_b32 s40, s3, 12
    s_lshl_b32 s41, s41, 8
    s_add_u32 s40, s40, s41
    s_cmp_ge_u32 s4, 30
    s_cselect_b32 s41, s1, s61
    s_add_u32 s40, s40, s41
    s_add_u32 s40, s40, 1245184
    v_lshlrev_b32 v47, 3, v41
    v_and_b32 v41, 7, v42
    v_lshl_add_u32 v47, v41, 5, v47
    v_lshrrev_b32 v41, 3, v42
    v_lshl_add_u32 v47, v41, 2, v47
    v_add_u32 v47, s40, v47
    s_lshl_b32 s41, s4, 2
    s_add_u32 s41, s41, s5
    s_mov_b32 s44, 0
    s_cmp_eq_u32 s41, 125
    s_cselect_b32 s45, -1, 0
    v_mov_b32 v41, 2147418112
    v_cndmask_b32 v47, v47, v41, s[44:45]
    s_cmp_ge_u32 s4, 20
    s_cselect_b32 s40, 0, 1073741824
    v_or_b32 v47, s40, v47
    buffer_store_dword v24, v47, s[16:19], s35 offen sc1
    v_mov_b32 v43, v28
    v_mov_b32 v44, v29
    s_waitcnt vmcnt(0)
    s_barrier
    s_and_b32 s41, s4, 3
    s_lshl_b32 s41, s41, 3
    s_lshl_b32 s40, 0x40, s41
    v_mov_b32 v24, s40
    s_lshl_b32 s40, s3, 5
    s_add_u32 s40, s40, s4
    s_and_b32 s40, s40, 0xfc
    v_lshlrev_b32 v25, 8, v0
    v_add_u32 v25, s40, v25
    buffer_atomic_or v24, v25, s[96:99], 0 offen sc1
    v_lshlrev_b32 v40, 2, v1
    s_mov_b32 s38, 0
L_slow2:
    buffer_load_dword v24, v40, s[96:99], 0 offen sc1
    s_add_u32 s38, s38, 1
    s_cmp_gt_u32 s38, 100000
    s_cbranch_scc1 L_abort
    s_waitcnt vmcnt(0)
    v_and_b32 v24, 0x40404040, v24
    s_mov_b32 s40, 0x40404040
    v_cmp_eq_u32 s[42:43], s40, v24
    s_lshl_b32 s41, s3, 3
    s_nop 0
    s_lshr_b64 s[42:43], s[42:43], s41
    s_and_b32 s42, s42, 0xff
    s_cmp_lg_u32 s42, 0xff
    s_cbranch_scc1 L_slow2
L_slowq:
    s_lshl_b32 s40, s6, 14
    s_lshl_b32 s41, s7, 6
    s_add_u32 s40, s40, s41
    v_lshrrev_b32 v41, 3, v1
    v_lshlrev_b32 v41, 9, v41
    v_add_u32 v41, s40, v41
    v_and_b32 v42, 7, v1
    v_lshl_add_u32 v41, v42, 3, v41
    s_add_u32 s82, s35, 0
    s_add_u32 s83, s35, 4096
    s_add_u32 s86, s35, 8192
    s_add_u32 s87, s35, 12288
    s_lshl_b32 s59, s6, 11
    s_add_u32 s59, s59, 1310720
    v_lshlrev_b32 v40, 3, v1
    s_mov_b32 s38, 0
Lpoll_3:
    buffer_load_dwordx2 v[16:17], v41, s[16:19], s82 offen offset:0 sc1
    buffer_load_dwordx2 v[18:19], v41, s[16:19], s83 offen offset:0 sc1
    buffer_load_dwordx2 v[20:21], v41, s[16:19], s86 offen offset:0 sc1
    buffer_load_dwordx2 v[22:23], v41, s[16:19], s87 offen offset:0 sc1
    buffer_load_dwordx2 v[32:33], v40, s[16:19], s59 offen offset:0 sc1
    buffer_load_dwordx2 v[34:35], v40, s[16:19], s59 offen offset:512 sc1
    buffer_load_dwordx2 v[36:37], v40, s[16:19], s59 offen offset:1024 sc1
    buffer_load_dwordx2 v[38:39], v40, s[16:19], s59 offen offset:1536 sc1
    s_add_u32 s38, s38, 1
    s_cmp_gt_u32 s38, 100000
    s_cbranch_scc1 L_abort
Lpw_4:
    s_waitcnt vmcnt(0)
    v_max3_u32 v42, v16, v17, v18
    v_max3_u32 v42, v42, v19, v20
    v_max3_u32 v42, v42, v21, v22
    v_max3_u32 v42, v42, v23, v32
    v_max3_u32 v42, v42, v33, v34
    v_max3_u32 v42, v42, v35, v36
    v_max3_u32 v42, v42, v37, v38
    v_max_u32 v42, v42, v39
    v_cmp_eq_u32 vcc, -1, v42
    s_cbranch_vccnz Lpoll_3
    s_branch L_att0
L_qpoll:
    buffer_load_dwordx4 v[56:59], v46, s[16:19], s58 offen offset:0 sc1
    buffer_load_dwordx4 v[60:63], v47, s[16:19], s58 offen offset:0 sc1
    s_cmp_lt_u32 s4, 20
    s_cselect_b32 s40, 15616, 0
    s_cmp_ge_u32 s4, 20
    s_cmov_b32 s40, 14592
    v_lshlrev_b32 v34, 3, v1
    v_add_u32 v34, s40, v34
    ds_read_b64 v[32:33], v34
    s_lshl_b32 s40, s5, 8
    s_add_u32 s40, s40, 10368
    s_lshl_b32 s41, s5, 9
    v_and_b32 v24, 1, v1
    v_lshrrev_b32 v25, 1, v1
    v_lshlrev_b32 v4, 7, v24
    v_lshl_add_u32 v4, v25, 2, v4
    v_add_u32 v4, s40, v4
    v_mul_u32_u24 v5, 0xaaaa, v24
    v_add_u32 v5, 0x4444, v5
    v_lshrrev_b32 v25, 4, v1
    v_lshlrev_b32 v26, 7, v24
    v_lshl_add_u32 v26, v25, 4, v26
    v_add_u32 v26, s40, v26
    v_mov_b32 v27, 16128
    s_mov_b32 s44, 0x000f000f
    s_mov_b32 s45, 0x000f000f
    v_cndmask_b32 v65, v27, v26, s[44:45]
    s_lshl_b64 s[44:45], s[44:45], 4
    v_cndmask_b32 v66, v27, v26, s[44:45]
    s_lshl_b64 s[44:45], s[44:45], 4
    v_cndmask_b32 v67, v27, v26, s[44:45]
    s_lshl_b64 s[44:45], s[44:45], 4
    v_cndmask_b32 v68, v27, v26, s[44:45]
    v_lshlrev_b32 v2, 5, v25
    v_lshl_add_u32 v2, v24, 4, v2
    v_add_u32 v2, s41, v2
    v_lshlrev_b32 v3, 4, v25
    v_add_u32 v3, s41, v3
    v_mov_b32 v27, 15744
    v_cmp_eq_u32 vcc, 1, v24
    v_bfe_u32 v28, v1, 3, 1
    v_lshlrev_b32 v29, 5, v28
    v_cndmask_b32 v3, v3, v27, vcc
    v_bfe_u32 v28, v1, 1, 1
    v_lshl_add_u32 v29, v28, 4, v29
    v_bfe_u32 v28, v1, 2, 1
    v_lshl_add_u32 v29, v28, 3, v29
    v_bfe_u32 v28, v1, 4, 1
    v_lshl_add_u32 v29, v28, 2, v29
    v_lshl_add_u32 v29, v24, 1, v29
    v_add_u32 v29, s41, v29
    v_bfe_u32 v30, v1, 2, 2
    v_lshlrev_b32 v30, 4, v30
    v_lshl_add_u32 v30, v28, 3, v30
    v_and_b32 v31, 3, v1
    v_lshl_add_u32 v30, v31, 1, v30
    v_add_u32 v30, s41, v30
    v_add_u32 v31, 64, v29
    s_mov_b32 vcc_lo, 0
    s_mov_b32 vcc_hi, -1
    v_cndmask_b32 v69, v29, v31, vcc
    v_add_u32 v31, 256, v29
    v_add_u32 v28, 384, v30
    v_cndmask_b32 v70, v28, v31, vcc
    v_add_u32 v31, 320, v29
    v_add_u32 v28, 448, v30
    v_cndmask_b32 v71, v31, v28, vcc
    s_waitcnt vmcnt(0) lgkmcnt(0)
    v_max3_u32 v42, v56, v57, v58
    v_max3_u32 v42, v42, v59, v60
    v_max3_u32 v42, v42, v61, v62
    v_max_u32 v42, v42, v63
    v_cmp_eq_u32 vcc, -1, v42
    s_cbranch_vccz L_rowok
    s_mov_b32 s38, 0
Lpoll_5:
    buffer_load_dwordx4 v[56:59], v46, s[16:19], s58 offen offset:0 sc1
    buffer_load_dwordx4 v[60:63], v47, s[16:19], s58 offen offset:0 sc1
    s_add_u32 s38, s38, 1
    s_cmp_gt_u32 s38, 100000
    s_cbranch_scc1 L_abort
Lpw_6:
    s_waitcnt vmcnt(0)
    v_max3_u32 v42, v56, v57, v58
    v_max3_u32 v42, v42, v59, v60
    v_max3_u32 v42, v42, v61, v62
    v_max_u32 v42, v42, v63
    v_cmp_eq_u32 vcc, -1, v42
    s_cbranch_vccnz Lpoll_5
L_rowok:
    buffer_load_dwordx2 v[16:17], v41, s[16:19], s82 offen offset:0 sc1
    buffer_load_dwordx2 v[18:19], v41, s[16:19], s83 offen offset:0 sc1
    buffer_load_dwordx2 v[20:21], v41, s[16:19], s86 offen offset:0 sc1
    buffer_load_dwordx2 v[22:23], v41, s[16:19], s87 offen offset:0 sc1
    v_dot2_f32_bf16 v43, v56, s54, 0
    v_dot2_f32_bf16 v44, v56, v56, 0
    v_dot2_f32_bf16 v43, v57, s54, v43
    v_dot2_f32_bf16 v44, v57, v57, v44
    v_dot2_f32_bf16 v43, v58, s54, v43
    v_dot2_f32_bf16 v44, v58, v58, v44
    v_dot2_f32_bf16 v43, v59, s54, v43
    v_dot2_f32_bf16 v44, v59, v59, v44
    v_dot2_f32_bf16 v43, v60, s54, v43
    v_dot2_f32_bf16 v44, v60, v60, v44
    v_dot2_f32_bf16 v43, v61, s54, v43
    v_dot2_f32_bf16 v44, v61, v61, v44
    v_dot2_f32_bf16 v43, v62, s54, v43
    v_dot2_f32_bf16 v44, v62, v62, v44
    v_dot2_f32_bf16 v43, v63, s54, v43
    v_dot2_f32_bf16 v44, v63, v63, v44
    s_nop 2
    v_add_f32_dpp v43, v43, v43 quad_perm:[1,0,3,2] row_mask:0xf bank_mask:0xf
    v_add_f32_dpp v44, v44, v44 quad_perm:[1,0,3,2] row_mask:0xf bank_mask:0xf
    s_nop 0
    v_add_f32_dpp v43, v43, v43 quad_perm:[2,3,0,1] row_mask:0xf bank_mask:0xf
    v_add_f32_dpp v44, v44, v44 quad_perm:[2,3,0,1] row_mask:0xf bank_mask:0xf
    s_nop 0
    v_add_f32_dpp v43, v43, v43 row_half_mirror row_mask:0xf bank_mask:0xf
    v_add_f32_dpp v44, v44, v44 row_half_mirror row_mask:0xf bank_mask:0xf
    s_nop 0
    v_add_f32_dpp v43, v43, v43 row_mirror row_mask:0xf bank_mask:0xf
    v_add_f32_dpp v44, v44, v44 row_mirror row_mask:0xf bank_mask:0xf
    s_nop 0
    v_mov_b32 v56, v43
    v_mov_b32 v57, v44
    s_nop 0
    v_permlane16_swap_b32 v43, v56
    v_permlane16_swap_b32 v44, v57
    s_nop 0
    v_add_f32 v43, v43, v56
    v_add_f32 v44, v44, v57
    v_mov_b32 v56, v43
    v_mov_b32 v57, v44
    s_nop 0
    v_permlane32_swap_b32 v43, v56
    v_permlane32_swap_b32 v44, v57
    s_nop 0
    v_add_f32 v43, v43, v56
    v_add_f32 v44, v44, v57
    v_mul_f32 v56, 0x3acccccd, v43
    v_mul_f32 v44, 0x3acccccd, v44
    v_fma_f32 v44, -v56, v56, v44
    v_max_f32 v44, 0, v44
    v_add_f32 v44, 0x3727c5ac, v44
    v_rsq_f32 v43, v44
    s_nop 0
    v_mul_f32 v44, -v56, v43
    v_mov_b32 v48, 0
    v_mov_b32 v49, 0
    v_mov_b32 v52, 0
    v_mov_b32 v53, 0
    v_mov_b32 v56, 0
    v_mov_b32 v57, 0
    v_mov_b32 v60, 0
    v_mov_b32 v61, 0
    s_waitcnt vmcnt(0)
    v_max3_u32 v42, v16, v17, v18
    v_max3_u32 v42, v42, v19, v20
    v_max3_u32 v42, v42, v21, v22
    v_max_u32 v42, v42, v23
    v_cmp_eq_u32 vcc, -1, v42
    s_cbranch_vccz L_qok
    s_mov_b32 s38, 0
Lpoll_7:
    buffer_load_dwordx2 v[16:17], v41, s[16:19], s82 offen offset:0 sc1
    buffer_load_dwordx2 v[18:19], v41, s[16:19], s83 offen offset:0 sc1
    buffer_load_dwordx2 v[20:21], v41, s[16:19], s86 offen offset:0 sc1
    buffer_load_dwordx2 v[22:23], v41, s[16:19], s87 offen offset:0 sc1
    s_add_u32 s38, s38, 1
    s_cmp_gt_u32 s38, 100000
    s_cbranch_scc1 L_abort
Lpw_8:
    s_waitcnt vmcnt(0)
    v_max3_u32 v42, v16, v17, v18
    v_max3_u32 v42, v42, v19, v20
    v_max3_u32 v42, v42, v21, v22
    v_max_u32 v42, v42, v23
    v_cmp_eq_u32 vcc, -1, v42
    s_cbranch_vccnz Lpoll_7
L_qok:
    s_branch L_att1
L_att0:
    v_pk_add_f32 v[32:33], v[32:33], v[34:35]
    v_pk_add_f32 v[36:37], v[36:37], v[38:39]
    s_cmp_lt_u32 s4, 20
    s_cselect_b32 s40, 15616, 0
    s_cmp_ge_u32 s4, 20
    s_cmov_b32 s40, 14592
    v_lshlrev_b32 v34, 3, v1
    v_add_u32 v34, s40, v34
    v_pk_add_f32 v[32:33], v[32:33], v[36:37]
    ds_write_b64 v34, v[32:33]
L_att1:
    v_pk_add_f32 v[16:17], v[16:17], v[18:19]
    v_pk_add_f32 v[20:21], v[20:21], v[22:23]
    v_pk_add_f32 v[16:17], v[16:17], v[20:21]
    v_mul_f32 v16, v16, v43
    v_mul_f32 v17, v17, v43
    v_fmac_f32 v16, v32, v44
    v_fmac_f32 v17, v33, v44
    v_cvt_pk_bf16_f32 v16, v16, v17
    ds_write_b32 v4, v16
    s_waitcnt lgkmcnt(0)
    ds_read_b128 v[16:19], v65 offset:0
    ds_read_b128 v[20:23], v65 offset:64
    ds_read_b128 v[24:27], v66 offset:0
    ds_read_b128 v[28:31], v66 offset:64
    ds_read_b128 v[32:35], v67 offset:0
    ds_read_b128 v[36:39], v67 offset:64
    ds_read_b128 v[40:43], v68 offset:0
    ds_read_b128 v[44:47], v68 offset:64
    s_cmp_eq_u32 s36, 0
    s_cselect_b64 vcc, -1, 0
    s_waitcnt lgkmcnt(7)
    v_smfmac_f32_16x16x64_bf16 v[48:51], v[16:19], a[0:7], v5
    s_waitcnt lgkmcnt(6)
    v_smfmac_f32_16x16x64_bf16 v[48:51], v[20:23], a[8:15], v5
    s_waitcnt lgkmcnt(5)
    v_smfmac_f32_16x16x64_bf16 v[48:51], v[24:27], a[16:23], v5
    s_waitcnt lgkmcnt(4)
    v_smfmac_f32_16x16x64_bf16 v[48:51], v[28:31], a[24:31], v5
    s_waitcnt lgkmcnt(3)
    v_smfmac_f32_16x16x64_bf16 v[48:51], v[32:35], a[32:39], v5
    s_waitcnt lgkmcnt(2)
    v_smfmac_f32_16x16x64_bf16 v[48:51], v[36:39], a[40:47], v5
    s_cbranch_vccz Lhk_9
    s_waitcnt vmcnt(21)
    ds_read_b64_tr_b16 v[150:151], v8 offset:12288
    ds_read_b64_tr_b16 v[158:159], v9 offset:12288
    ds_read_b64_tr_b16 v[166:167], v10 offset:12288
    ds_read_b64_tr_b16 v[174:175], v11 offset:12288
    ds_read_b64_tr_b16 v[182:183], v12 offset:12288
    ds_read_b64_tr_b16 v[190:191], v13 offset:12288
    ds_read_b64_tr_b16 v[198:199], v14 offset:12288
    ds_read_b64_tr_b16 v[206:207], v15 offset:12288
    s_waitcnt lgkmcnt(0)
Lhk_9:
    s_waitcnt lgkmcnt(1)
    v_smfmac_f32_16x16x64_bf16 v[48:51], v[40:43], a[48:55], v5
    s_waitcnt lgkmcnt(0)
    v_smfmac_f32_16x16x64_bf16 v[48:51], v[44:47], a[56:63], v5
    v_smfmac_f32_16x16x64_bf16 v[52:55], v[16:19], a[64:71], v5
    v_smfmac_f32_16x16x64_bf16 v[52:55], v[20:23], a[72:79], v5
    v_smfmac_f32_16x16x64_bf16 v[52:55], v[24:27], a[80:87], v5
    v_smfmac_f32_16x16x64_bf16 v[52:55], v[28:31], a[88:95], v5
    s_cbranch_vccz Lhk_10
    s_add_u32 m0, s34, 28672
    s_nop 0
    buffer_load_dwordx4 v6, s[12:15], s33 offen offset:0 nt lds
    s_waitcnt vmcnt(5)
Lhk_10:
    v_smfmac_f32_16x16x64_bf16 v[52:55], v[32:35], a[96:103], v5
    v_smfmac_f32_16x16x64_bf16 v[52:55], v[36:39], a[104:111], v5
    v_smfmac_f32_16x16x64_bf16 v[52:55], v[40:43], a[112:119], v5
    v_smfmac_f32_16x16x64_bf16 v[52:55], v[44:47], a[120:127], v5
    v_add_f32 v65, v48, v49
    v_smfmac_f32_16x16x64_bf16 v[56:59], v[16:19], a[128:135], v5
    v_smfmac_f32_16x16x64_bf16 v[56:59], v[20:23], a[136:143], v5
    s_cbranch_vccz Lhk_11
    buffer_load_dwordx4 v7, s[12:15], s33 offen offset:1024 nt lds
    s_waitcnt vmcnt(5)
Lhk_11:
    v_smfmac_f32_16x16x64_bf16 v[56:59], v[24:27], a[144:151], v5
    v_smfmac_f32_16x16x64_bf16 v[56:59], v[28:31], a[152:159], v5
    v_smfmac_f32_16x16x64_bf16 v[56:59], v[32:35], a[160:167], v5
    v_smfmac_f32_16x16x64_bf16 v[56:59], v[36:39], a[168:175], v5
    v_smfmac_f32_16x16x64_bf16 v[56:59], v[40:43], a[176:183], v5
    v_smfmac_f32_16x16x64_bf16 v[56:59], v[44:47], a[184:191], v5
    v_add_f32 v66, v52, v53
    s_cbranch_vccz Lhk_12
    buffer_load_dwordx4 v6, s[12:15], s33 offen offset:2048 nt lds
    s_waitcnt vmcnt(5)
Lhk_12:
    v_smfmac_f32_16x16x64_bf16 v[60:63], v[16:19], a[192:199], v5
    v_smfmac_f32_16x16x64_bf16 v[60:63], v[20:23], a[200:207], v5
    v_smfmac_f32_16x16x64_bf16 v[60:63], v[24:27], a[208:215], v5
    v_smfmac_f32_16x16x64_bf16 v[60:63], v[28:31], a[216:223], v5
    v_smfmac_f32_16x16x64_bf16 v[60:63], v[32:35], a[224:231], v5
    v_smfmac_f32_16x16x64_bf16 v[60:63], v[36:39], a[232:239], v5
    s_cbranch_vccz Lhk_13
    buffer_load_dwordx4 v7, s[12:15], s33 offen offset:3072 nt lds
    s_waitcnt vmcnt(5)
    s_add_u32 s33, s33, 16384
Lhk_13:
    v_smfmac_f32_16x16x64_bf16 v[60:63], v[40:43], v[124:131], v5
    v_smfmac_f32_16x16x64_bf16 v[60:63], v[44:47], v[132:139], v5
    v_add_f32 v67, v56, v57
    s_nop 7
    v_add_f32 v68, v60, v61
    v_max3_f32 v64, v65, v66, v67
    v_max_f32 v64, v64, v68
    s_nop 1
    v_max_f32_dpp v64, v64, v64 quad_perm:[1,0,3,2] row_mask:0xf bank_mask:0xf
    s_nop 1
    v_max_f32_dpp v64, v64, v64 quad_perm:[2,3,0,1] row_mask:0xf bank_mask:0xf
    s_nop 1
    v_max_f32_dpp v64, v64, v64 row_half_mirror row_mask:0xf bank_mask:0xf
    s_nop 1
    v_max_f32_dpp v64, v64, v64 row_mirror row_mask:0xf bank_mask:0xf
    v_mov_b32 v20, v64
    s_nop 1
    v_permlane16_swap_b32 v64, v20
    s_nop 0
    v_max_f32 v64, v64, v20
    v_mov_b32 v20, v64
    s_nop 1
    v_permlane32_swap_b32 v64, v20
    s_nop 0
    v_max_f32 v64, v64, v20
    s_mov_b32 s40, 0x3e0293ee
    v_mul_f32 v140, s40, v64
    v_fma_f32 v65, v65, s40, -v140
    v_fma_f32 v66, v66, s40, -v140
    v_fma_f32 v67, v67, s40, -v140
    v_fma_f32 v68, v68, s40, -v140
    v_exp_f32 v65, v65
    v_exp_f32 v66, v66
    v_exp_f32 v67, v67
    v_exp_f32 v68, v68
    v_mov_b32 v22, v140
    v_cvt_pk_bf16_f32 v16, v65, v66
    v_cvt_pk_bf16_f32 v17, v67, v68
    ds_write_b16 v70, v17
    ds_write_b16 v69, v16
    ds_write_b16_d16_hi v71, v17
    ds_write_b16_d16_hi v69, v16 offset:128
    v_add_f32 v18, v65, v66
    v_add_f32 v19, v67, v68
    s_lshl_b32 s40, s5, 3
    v_add_f32 v4, v18, v19
    v_mov_b32 v18, s40
    ds_write_b32 v18, v22 offset:14464
    s_cbranch_vccz Lhk_14
    s_waitcnt vmcnt(12)
    ds_read_b64_tr_b16 v[208:209], v8 offset:16384
    ds_read_b64_tr_b16 v[216:217], v9 offset:16384
    ds_read_b64_tr_b16 v[224:225], v10 offset:16384
    ds_read_b64_tr_b16 v[232:233], v11 offset:16384
    ds_read_b64_tr_b16 v[240:241], v12 offset:16384
    ds_read_b64_tr_b16 v[248:249], v13 offset:16384
    ds_read_b64_tr_b16 a[240:241], v14 offset:16384
    ds_read_b64_tr_b16 a[248:249], v15 offset:16384
    s_waitcnt lgkmcnt(0)
    s_add_u32 m0, s34, 0
    s_nop 0
    buffer_load_dwordx4 v6, s[12:15], s33 offen offset:0 nt lds
    s_waitcnt vmcnt(5)
    buffer_load_dwordx4 v7, s[12:15], s33 offen offset:1024 nt lds
    s_waitcnt vmcnt(5)
    buffer_load_dwordx4 v6, s[12:15], s33 offen offset:2048 nt lds
    s_waitcnt vmcnt(5)
    buffer_load_dwordx4 v7, s[12:15], s33 offen offset:3072 nt lds
    s_waitcnt vmcnt(5)
    s_add_u32 s33, s33, 16384
    s_waitcnt vmcnt(12)
    ds_read_b64_tr_b16 v[210:211], v8 offset:20480
    ds_read_b64_tr_b16 v[218:219], v9 offset:20480
    ds_read_b64_tr_b16 v[226:227], v10 offset:20480
    ds_read_b64_tr_b16 v[234:235], v11 offset:20480
    ds_read_b64_tr_b16 v[242:243], v12 offset:20480
    ds_read_b64_tr_b16 v[250:251], v13 offset:20480
    ds_read_b64_tr_b16 a[242:243], v14 offset:20480
    ds_read_b64_tr_b16 a[250:251], v15 offset:20480
    s_waitcnt lgkmcnt(0)
    s_add_u32 m0, s34, 4096
    s_nop 0
    buffer_load_dwordx4 v6, s[12:15], s33 offen offset:0 nt lds
    s_waitcnt vmcnt(5)
    buffer_load_dwordx4 v7, s[12:15], s33 offen offset:1024 nt lds
    s_waitcnt vmcnt(5)
    buffer_load_dwordx4 v6, s[12:15], s33 offen offset:2048 nt lds
    s_waitcnt vmcnt(5)
    buffer_load_dwordx4 v7, s[12:15], s33 offen offset:3072 nt lds
    s_waitcnt vmcnt(5)
    s_add_u32 s33, s33, 16384
    s_waitcnt vmcnt(12)
    ds_read_b64_tr_b16 v[212:213], v8 offset:24576
    ds_read_b64_tr_b16 v[220:221], v9 offset:24576
    ds_read_b64_tr_b16 v[228:229], v10 offset:24576
    ds_read_b64_tr_b16 v[236:237], v11 offset:24576
    ds_read_b64_tr_b16 v[244:245], v12 offset:24576
    ds_read_b64_tr_b16 v[252:253], v13 offset:24576
    ds_read_b64_tr_b16 a[244:245], v14 offset:24576
    ds_read_b64_tr_b16 a[252:253], v15 offset:24576
    s_waitcnt lgkmcnt(0)
    s_add_u32 m0, s34, 8192
    s_nop 0
    buffer_load_dwordx4 v6, s[12:15], s33 offen offset:0 nt lds
    s_waitcnt vmcnt(5)
    buffer_load_dwordx4 v7, s[12:15], s33 offen offset:1024 nt lds
    s_waitcnt vmcnt(5)
    buffer_load_dwordx4 v6, s[12:15], s33 offen offset:2048 nt lds
    s_waitcnt vmcnt(5)
    buffer_load_dwordx4 v7, s[12:15], s33 offen offset:3072 nt lds
    s_waitcnt vmcnt(5)
    s_add_u32 s33, s33, 16384
    s_waitcnt vmcnt(12)
    ds_read_b64_tr_b16 v[214:215], v8 offset:28672
    ds_read_b64_tr_b16 v[222:223], v9 offset:28672
    ds_read_b64_tr_b16 v[230:231], v10 offset:28672
    ds_read_b64_tr_b16 v[238:239], v11 offset:28672
    ds_read_b64_tr_b16 v[246:247], v12 offset:28672
    ds_read_b64_tr_b16 v[254:255], v13 offset:28672
    ds_read_b64_tr_b16 a[246:247], v14 offset:28672
    ds_read_b64_tr_b16 a[254:255], v15 offset:28672
    s_waitcnt lgkmcnt(0)
    s_add_u32 m0, s34, 12288
    s_nop 0
    buffer_load_dwordx4 v6, s[12:15], s33 offen offset:0 nt lds
    s_waitcnt vmcnt(5)
    buffer_load_dwordx4 v7, s[12:15], s33 offen offset:1024 nt lds
    s_waitcnt vmcnt(5)
    buffer_load_dwordx4 v6, s[12:15], s33 offen offset:2048 nt lds
    s_waitcnt vmcnt(5)
    buffer_load_dwordx4 v7, s[12:15], s33 offen offset:3072 nt lds
    s_waitcnt vmcnt(5)
    s_add_u32 s33, s33, 16384
    s_waitcnt vmcnt(12)
    ds_read_b64_tr_b16 v[92:93], v8 offset:0
    ds_read_b64_tr_b16 v[96:97], v9 offset:0
    ds_read_b64_tr_b16 v[100:101], v10 offset:0
    ds_read_b64_tr_b16 v[104:105], v11 offset:0
    ds_read_b64_tr_b16 v[108:109], v12 offset:0
    ds_read_b64_tr_b16 v[112:113], v13 offset:0
    ds_read_b64_tr_b16 v[116:117], v14 offset:0
    ds_read_b64_tr_b16 v[120:121], v15 offset:0
    s_waitcnt lgkmcnt(0)
    s_add_u32 m0, s34, 16384
    s_nop 0
    buffer_load_dwordx4 v6, s[12:15], s33 offen offset:0 nt lds
    s_waitcnt vmcnt(5)
    buffer_load_dwordx4 v7, s[12:15], s33 offen offset:1024 nt lds
    s_waitcnt vmcnt(5)
    buffer_load_dwordx4 v6, s[12:15], s33 offen offset:2048 nt lds
    s_waitcnt vmcnt(5)
    buffer_load_dwordx4 v7, s[12:15], s33 offen offset:3072 nt lds
    s_waitcnt vmcnt(5)
    s_add_u32 s33, s33, 16384
    s_waitcnt vmcnt(12)
    ds_read_b64_tr_b16 v[94:95], v8 offset:4096
    ds_read_b64_tr_b16 v[98:99], v9 offset:4096
    ds_read_b64_tr_b16 v[102:103], v10 offset:4096
    ds_read_b64_tr_b16 v[106:107], v11 offset:4096
    ds_read_b64_tr_b16 v[110:111], v12 offset:4096
    ds_read_b64_tr_b16 v[114:115], v13 offset:4096
    ds_read_b64_tr_b16 v[118:119], v14 offset:4096
    ds_read_b64_tr_b16 v[122:123], v15 offset:4096
    s_waitcnt lgkmcnt(0)
    s_add_u32 m0, s34, 20480
    s_nop 0
    buffer_load_dwordx4 v6, s[12:15], s33 offen offset:0 nt lds
    s_waitcnt vmcnt(5)
    buffer_load_dwordx4 v7, s[12:15], s33 offen offset:1024 nt lds
    s_waitcnt vmcnt(5)
    buffer_load_dwordx4 v6, s[12:15], s33 offen offset:2048 nt lds
    s_waitcnt vmcnt(5)
    buffer_load_dwordx4 v7, s[12:15], s33 offen offset:3072 nt lds
    s_waitcnt vmcnt(5)
    s_add_u32 s33, s33, 16384
    s_add_u32 m0, s34, 24576
    s_nop 0
    buffer_load_dwordx4 v6, s[12:15], s33 offen offset:0 nt lds
    buffer_load_dwordx4 v7, s[12:15], s33 offen offset:1024 nt lds
    buffer_load_dwordx4 v6, s[12:15], s33 offen offset:2048 nt lds
    buffer_load_dwordx4 v7, s[12:15], s33 offen offset:3072 nt lds
    s_add_u32 s33, s33, 16384
    s_add_u32 m0, s34, 28672
    s_nop 0
    buffer_load_dwordx4 v6, s[12:15], s33 offen offset:0 nt lds
    buffer_load_dwordx4 v7, s[12:15], s33 offen offset:1024 nt lds
    buffer_load_dwordx4 v6, s[12:15], s33 offen offset:2048 nt lds
    buffer_load_dwordx4 v7, s[12:15], s33 offen offset:3072 nt lds
    s_add_u32 s33, s33, 16384
    s_mul_i32 s42, s3, 276480
    s_add_u32 s42, s80, s42
    s_addc_u32 s43, s81, 0
    s_cmp_lt_u32 s4, 20
    s_cselect_b32 s20, s72, s42
    s_cselect_b32 s21, s73, s43
    s_mov_b32 s22, 276480
    s_cmov_b32 s22, 5242880
    s_mov_b32 s23, 0x20000
    s_cmp_ge_u32 s4, 30
    s_cmov_b32 s22, 0
    s_cmp_ge_u32 s4, 10
    s_cselect_b32 s40, 2, 0
    s_lshr_b32 s41, s5, 1
    s_add_u32 s40, s40, s41
    s_mul_i32 s41, s40, 1
    s_add_u32 s41, s41, s3
    s_and_b32 s41, s41, 7
    s_lshl_b32 s40, s40, 3
    s_add_u32 s40, s40, s41
    s_lshl_b32 s40, s40, 1
    s_and_b32 s41, s5, 1
    s_add_u32 s40, s40, s41
    s_cmp_lt_u32 s4, 20
    s_cselect_b32 s40, s40, s5
    s_mul_i32 s40, s40, 81920
    s_lshl_b32 s41, s78, 7
    s_add_u32 s40, s40, s41
    s_mov_b32 s58, s34
    s_lshl_b32 s41, s5, 8
    s_add_u32 s41, s41, s4
    s_cmp_ge_u32 s41, 788
    s_cmov_b32 s58, 163840
    v_lshrrev_b32 v23, 3, v1
    v_mul_u32_u24 v24, 1280, v23
    v_and_b32 v23, 7, v1
    v_lshl_add_u32 v23, v23, 4, v24
    s_add_u32 m0, s34, 0
    s_nop 0
    buffer_load_dwordx4 v23, s[20:23], s40 offen nt lds
    s_add_u32 s40, s40, 10240
    s_add_u32 m0, s34, 1024
    s_nop 0
    buffer_load_dwordx4 v23, s[20:23], s40 offen nt lds
    s_add_u32 s40, s40, 10240
    s_add_u32 m0, s34, 2048
    s_nop 0
    buffer_load_dwordx4 v23, s[20:23], s40 offen nt lds
    s_add_u32 s40, s40, 10240
    s_add_u32 m0, s34, 3072
    s_nop 0
    buffer_load_dwordx4 v23, s[20:23], s40 offen nt lds
    s_add_u32 s40, s40, 10240
    s_add_u32 m0, s58, 4096
    s_nop 0
    buffer_load_dwordx4 v23, s[20:23], s40 offen nt lds
    s_add_u32 s40, s40, 10240
    s_add_u32 m0, s58, 5120
    s_nop 0
    buffer_load_dwordx4 v23, s[20:23], s40 offen nt lds
    s_add_u32 s40, s40, 10240
    s_add_u32 m0, s58, 6144
    s_nop 0
    buffer_load_dwordx4 v23, s[20:23], s40 offen nt lds
    s_add_u32 s40, s40, 10240
    s_add_u32 m0, s58, 7168
    s_nop 0
    buffer_load_dwordx4 v23, s[20:23], s40 offen nt lds
Lhk_14:
    s_waitcnt vmcnt(16)
    ds_read_b64_tr_b16 v[32:33], v8 offset:8192
    ds_read_b64_tr_b16 v[34:35], v8 offset:12288
    ds_read_b64_tr_b16 v[36:37], v8 offset:16384
    ds_read_b64_tr_b16 v[38:39], v8 offset:20480
    ds_read_b64_tr_b16 v[40:41], v9 offset:8192
    ds_read_b64_tr_b16 v[42:43], v9 offset:12288
    ds_read_b64_tr_b16 v[44:45], v9 offset:16384
    ds_read_b64_tr_b16 v[46:47], v9 offset:20480
    ds_read_b128 v[16:19], v3 offset:384
    ds_read_b128 v[20:23], v2 offset:0
    ds_read_b128 v[140:143], v2 offset:256
    s_waitcnt lgkmcnt(2)
    v_mfma_f32_16x16x32_bf16 v[48:51], v[16:19], v[92:95], 0
    s_nop 0
    v_add_f32_dpp v4, v4, v4 quad_perm:[1,0,3,2] row_mask:0xf bank_mask:0xf
    v_mfma_f32_16x16x32_bf16 v[52:55], v[16:19], v[96:99], 0
    s_nop 0
    v_add_f32_dpp v4, v4, v4 quad_perm:[2,3,0,1] row_mask:0xf bank_mask:0xf
    v_mfma_f32_16x16x32_bf16 v[56:59], v[16:19], v[100:103], 0
    s_nop 0
    v_add_f32_dpp v4, v4, v4 row_half_mirror row_mask:0xf bank_mask:0xf
    v_mfma_f32_16x16x32_bf16 v[60:63], v[16:19], v[104:107], 0
    s_nop 0
    v_add_f32_dpp v4, v4, v4 row_mirror row_mask:0xf bank_mask:0xf
    v_mfma_f32_16x16x32_bf16 v[64:67], v[16:19], v[108:111], 0
    v_mov_b32 v6, v4
    v_mfma_f32_16x16x32_bf16 v[68:71], v[16:19], v[112:115], 0
    s_nop 0
    v_permlane16_swap_b32 v4, v6
    s_nop 0
    v_add_f32 v4, v4, v6
    v_mfma_f32_16x16x32_bf16 v[24:27], v[16:19], v[116:119], 0
    v_mov_b32 v6, v4
    v_mfma_f32_16x16x32_bf16 v[28:31], v[16:19], v[120:123], 0
    s_nop 0
    v_permlane32_swap_b32 v4, v6
    s_nop 0
    v_add_f32 v4, v4, v6
    s_lshl_b32 s40, s5, 3
    v_mov_b32 v6, s40
    ds_write_b32 v6, v4 offset:14468
    ds_read_b32 v4, v6 offset:14464
    ds_read_b128 v[16:19], v2 offset:128
    s_waitcnt lgkmcnt(1)
    v_smfmac_f32_16x16x64_bf16 v[48:51], v[20:23], v[144:151], v5
    v_smfmac_f32_16x16x64_bf16 v[52:55], v[20:23], v[152:159], v5
    v_smfmac_f32_16x16x64_bf16 v[48:51], v[140:143], v[32:39], v5
    ds_read_b64_tr_b16 v[32:33], v10 offset:8192
    ds_read_b64_tr_b16 v[34:35], v10 offset:12288
    ds_read_b64_tr_b16 v[36:37], v10 offset:16384
    ds_read_b64_tr_b16 v[38:39], v10 offset:20480
    v_smfmac_f32_16x16x64_bf16 v[56:59], v[20:23], v[160:167], v5
    v_smfmac_f32_16x16x64_bf16 v[60:63], v[20:23], v[168:175], v5
    v_smfmac_f32_16x16x64_bf16 v[52:55], v[140:143], v[40:47], v5
    ds_read_b64_tr_b16 v[40:41], v11 offset:8192
    ds_read_b64_tr_b16 v[42:43], v11 offset:12288
    ds_read_b64_tr_b16 v[44:45], v11 offset:16384
    ds_read_b64_tr_b16 v[46:47], v11 offset:20480
    v_smfmac_f32_16x16x64_bf16 v[64:67], v[20:23], v[176:183], v5
    v_smfmac_f32_16x16x64_bf16 v[68:71], v[20:23], v[184:191], v5
    s_waitcnt lgkmcnt(4)
    v_smfmac_f32_16x16x64_bf16 v[56:59], v[140:143], v[32:39], v5
    ds_read_b64_tr_b16 v[32:33], v12 offset:8192
    ds_read_b64_tr_b16 v[34:35], v12 offset:12288
    ds_read_b64_tr_b16 v[36:37], v12 offset:16384
    ds_read_b64_tr_b16 v[38:39], v12 offset:20480
    v_smfmac_f32_16x16x64_bf16 v[24:27], v[20:23], v[192:199], v5
    v_smfmac_f32_16x16x64_bf16 v[28:31], v[20:23], v[200:207], v5
    s_waitcnt lgkmcnt(4)
    v_smfmac_f32_16x16x64_bf16 v[60:63], v[140:143], v[40:47], v5
    ds_read_b64_tr_b16 v[40:41], v13 offset:8192
    ds_read_b64_tr_b16 v[42:43], v13 offset:12288
    ds_read_b64_tr_b16 v[44:45], v13 offset:16384
    ds_read_b64_tr_b16 v[46:47], v13 offset:20480
    ds_read_b128 v[20:23], v3 offset:448
    s_barrier
    v_and_b32 v2, 3, v1
    v_lshlrev_b32 v2, 3, v2
    ds_read_b64 v[6:7], v2 offset:14464
    v_smfmac_f32_16x16x64_bf16 v[48:51], v[16:19], v[208:215], v5
    s_waitcnt lgkmcnt(0)
    v_smfmac_f32_16x16x64_bf16 v[52:55], v[16:19], v[216:223], v5
    v_max_f32_dpp v3, v6, v6 quad_perm:[1,0,3,2] row_mask:0xf bank_mask:0xf
    v_smfmac_f32_16x16x64_bf16 v[64:67], v[140:143], v[32:39], v5
    ds_read_b64_tr_b16 v[32:33], v14 offset:8192
    ds_read_b64_tr_b16 v[34:35], v14 offset:12288
    ds_read_b64_tr_b16 v[36:37], v14 offset:16384
    ds_read_b64_tr_b16 v[38:39], v14 offset:20480
    v_smfmac_f32_16x16x64_bf16 v[56:59], v[16:19], v[224:231], v5
    s_nop 0
    v_max_f32_dpp v3, v3, v3 quad_perm:[2,3,0,1] row_mask:0xf bank_mask:0xf
    v_sub_f32 v6, v6, v3
    v_exp_f32 v6, v6
    v_smfmac_f32_16x16x64_bf16 v[60:63], v[16:19], v[232:239], v5
    v_sub_f32 v4, v4, v3
    v_mul_f32 v7, v6, v7
    v_exp_f32 v4, v4
    v_smfmac_f32_16x16x64_bf16 v[68:71], v[140:143], v[40:47], v5
    ds_read_b64_tr_b16 v[40:41], v15 offset:8192
    ds_read_b64_tr_b16 v[42:43], v15 offset:12288
    ds_read_b64_tr_b16 v[44:45], v15 offset:16384
    ds_read_b64_tr_b16 v[46:47], v15 offset:20480
    v_smfmac_f32_16x16x64_bf16 v[64:67], v[16:19], v[240:247], v5
    v_add_f32_dpp v7, v7, v7 quad_perm:[1,0,3,2] row_mask:0xf bank_mask:0xf
    s_lshl_b32 s40, s5, 9
    s_add_u32 s40, s40, 12416
    v_smfmac_f32_16x16x64_bf16 v[68:71], v[16:19], v[248:255], v5
    v_add_f32_dpp v7, v7, v7 quad_perm:[2,3,0,1] row_mask:0xf bank_mask:0xf
    v_lshlrev_b32 v2, 2, v1
    v_add_u32 v2, s40, v2
    s_waitcnt lgkmcnt(4)
    v_smfmac_f32_16x16x64_bf16 v[24:27], v[140:143], v[32:39], v5
    s_waitcnt vmcnt(8)
    ds_read_b64_tr_b16 v[32:33], v8 offset:24576
    ds_read_b64_tr_b16 v[34:35], v8 offset:28672
    ds_read_b64_tr_b16 v[36:37], v9 offset:24576
    ds_read_b64_tr_b16 v[38:39], v9 offset:28672
    v_smfmac_f32_16x16x64_bf16 v[24:27], v[16:19], a[240:247], v5
    v_rcp_f32 v7, v7
    v_lshlrev_b32 v3, 3, v1
    s_lshl_b32 s40, s6, 11
    s_lshl_b32 s41, s7, 8
    s_add_u32 s40, s40, s41
    v_smfmac_f32_16x16x64_bf16 v[28:31], v[16:19], a[248:255], v5
    v_mul_f32 v4, v4, v7
    s_add_u32 s40, s40, s61
    s_add_u32 s40, s40, 524288
    v_lshlrev_b32 v7, 2, v1
    v_add_u32 v7, s40, v7
    s_waitcnt lgkmcnt(4)
    v_smfmac_f32_16x16x64_bf16 v[28:31], v[140:143], v[40:47], v5
    ds_read_b64_tr_b16 v[40:41], v10 offset:24576
    ds_read_b64_tr_b16 v[42:43], v10 offset:28672
    ds_read_b64_tr_b16 v[44:45], v11 offset:24576
    ds_read_b64_tr_b16 v[46:47], v11 offset:28672
    s_waitcnt lgkmcnt(6)
    v_mfma_f32_16x16x32_bf16 v[48:51], v[20:23], v[32:35], v[48:51]
    ds_read_b64_tr_b16 v[32:33], v12 offset:24576
    ds_read_b64_tr_b16 v[34:35], v12 offset:28672
    s_waitcnt lgkmcnt(6)
    v_mfma_f32_16x16x32_bf16 v[52:55], v[20:23], v[36:39], v[52:55]
    ds_read_b64_tr_b16 v[36:37], v13 offset:24576
    ds_read_b64_tr_b16 v[38:39], v13 offset:28672
    s_waitcnt lgkmcnt(6)
    v_mfma_f32_16x16x32_bf16 v[56:59], v[20:23], v[40:43], v[56:59]
    ds_read_b64_tr_b16 v[40:41], v14 offset:24576
    ds_read_b64_tr_b16 v[42:43], v14 offset:28672
    s_waitcnt lgkmcnt(6)
    v_mfma_f32_16x16x32_bf16 v[60:63], v[20:23], v[44:47], v[60:63]
    ds_read_b64_tr_b16 v[44:45], v15 offset:24576
    ds_read_b64_tr_b16 v[46:47], v15 offset:28672
    s_waitcnt lgkmcnt(6)
    v_mfma_f32_16x16x32_bf16 v[64:67], v[20:23], v[32:35], v[64:67]
    s_waitcnt lgkmcnt(4)
    v_mfma_f32_16x16x32_bf16 v[68:71], v[20:23], v[36:39], v[68:71]
    s_waitcnt lgkmcnt(2)
    v_mfma_f32_16x16x32_bf16 v[24:27], v[20:23], v[40:43], v[24:27]
    s_waitcnt lgkmcnt(0)
    v_mfma_f32_16x16x32_bf16 v[28:31], v[20:23], v[44:47], v[28:31]
    s_nop 0
    v_add_f32 v48, v48, v49
    v_add_f32 v52, v52, v53
    v_add_f32 v56, v56, v57
    v_add_f32 v60, v60, v61
    v_add_f32 v64, v64, v65
    v_add_f32 v68, v68, v69
    v_add_f32 v24, v24, v25
    v_add_f32 v28, v28, v29
    v_cndmask_b32 v16, v48, v52, s[46:47]
    v_cndmask_b32 v16, v16, v56, s[48:49]
    v_cndmask_b32 v16, v16, v60, s[50:51]
    v_cndmask_b32 v17, v64, v68, s[46:47]
    v_cndmask_b32 v17, v17, v24, s[48:49]
    v_cndmask_b32 v17, v17, v28, s[50:51]
    v_mul_f32 v16, v16, v4
    v_mul_f32 v17, v17, v4
    ds_write2st64_b32 v2, v16, v17 offset0:0 offset1:1
    s_waitcnt lgkmcnt(0)
    s_barrier
    ds_read_b64 v[20:21], v3 offset:12416
    ds_read_b64 v[22:23], v3 offset:12928
    ds_read_b64 v[24:25], v3 offset:13440
    ds_read_b64 v[26:27], v3 offset:13952
    s_waitcnt lgkmcnt(2)
    v_pk_add_f32 v[20:21], v[20:21], v[22:23]
    s_waitcnt lgkmcnt(0)
    v_pk_add_f32 v[24:25], v[24:25], v[26:27]
    v_pk_add_f32 v[20:21], v[20:21], v[24:25]
    v_cvt_pk_bf16_f32 v20, v20, v21
    v_min_u32 v20, -2, v20
    s_cmp_eq_u32 s37, 1
    s_cbranch_scc1 Lpl_15
    buffer_store_dword v20, v7, s[16:19], s35 offen sc1
    s_branch Lpe_16
Lpl_15:
    buffer_store_dword v20, v7, s[16:19], s35 offen
Lpe_16:
    s_cmp_ge_u32 s4, 20
    s_cbranch_scc1 L_mlp
    v_lshrrev_b32 v16, 4, v1
    v_and_b32 v17, 15, v1
    s_cmp_ge_u32 s4, 10
    s_cselect_b32 s40, 2, 0
    s_lshr_b32 s41, s5, 1
    s_add_u32 s40, s40, s41
    s_mul_i32 s41, s40, 1
    s_add_u32 s41, s41, s3
    s_and_b32 s41, s41, 7
    s_lshl_b32 s40, s40, 3
    s_add_u32 s40, s40, s41
    s_lshl_b32 s40, s40, 11
    s_and_b32 s41, s5, 1
    s_lshl_b32 s41, s41, 7
    s_add_u32 s40, s40, s41
    s_add_u32 s40, s40, 524288
    v_and_b32 v17, 7, v17
    v_lshlrev_b32 v2, 8, v17
    v_lshl_add_u32 v2, v16, 4, v2
    v_add_u32 v2, s40, v2
    v_add_u32 v3, 64, v2
    buffer_load_dwordx4 v[16:19], v2, s[16:19], s35 offen offset:0 sc1
    buffer_load_dwordx4 v[20:23], v3, s[16:19], s35 offen offset:0 sc1
    v_lshrrev_b32 v25, 4, v1
    v_bfe_u32 v24, v1, 2, 2
    v_lshl_add_u32 v24, v25, 3, v24
    v_lshlrev_b32 v24, 7, v24
    v_and_b32 v25, 3, v1
    v_lshl_add_u32 v24, v25, 3, v24
    v_add_u32 v24, s34, v24
    s_waitcnt vmcnt(2)
    ds_read_b64_tr_b16 v[40:41], v24 offset:0
    ds_read_b64_tr_b16 v[42:43], v24 offset:512
    ds_read_b64_tr_b16 v[44:45], v24 offset:32
    ds_read_b64_tr_b16 v[46:47], v24 offset:544
    ds_read_b64_tr_b16 v[48:49], v24 offset:64
    ds_read_b64_tr_b16 v[50:51], v24 offset:576
    ds_read_b64_tr_b16 v[52:53], v24 offset:96
    ds_read_b64_tr_b16 v[54:55], v24 offset:608
    ds_read_b64_tr_b16 v[56:57], v24 offset:4096
    ds_read_b64_tr_b16 v[58:59], v24 offset:4608
    ds_read_b64_tr_b16 v[60:61], v24 offset:4128
    ds_read_b64_tr_b16 v[62:63], v24 offset:4640
    ds_read_b64_tr_b16 v[64:65], v24 offset:4160
    ds_read_b64_tr_b16 v[66:67], v24 offset:4672
    ds_read_b64_tr_b16 v[68:69], v24 offset:4192
    ds_read_b64_tr_b16 v[70:71], v24 offset:4704
    v_lshlrev_b32 v4, 4, v0
    s_and_b32 s40, s5, 1
    s_lshl_b32 s40, s40, 12
    v_lshlrev_b32 v5, 4, v1
    v_add_u32 v5, s40, v5
    v_lshrrev_b32 v25, 4, v1
    v_and_b32 v26, 15, v1
    s_cmp_lt_u32 s4, 20
    s_cselect_b32 s41, 14, 13
    s_lshl_b32 s40, s5, s41
    s_add_u32 s40, s40, s79
    s_add_u32 s40, s40, s1
    v_lshlrev_b32 v6, 7, v25
    v_and_b32 v25, 7, v26
    v_lshl_add_u32 v6, v25, 4, v6
    v_lshrrev_b32 v25, 3, v26
    v_lshl_add_u32 v6, v25, 9, v6
    v_add_u32 v6, s40, v6
    s_mul_i32 s40, s3, 640
    s_mul_i32 s41, s78, 32
    s_add_u32 s40, s40, s41
    s_mul_i32 s41, s5, 16
    s_add_u32 s40, s40, s41
    s_add_u32 s40, s40, s1
    s_add_u32 s40, s40, 1277952
    s_mov_b32 s41, 0
    s_cmp_ge_u32 s4, 10
    s_cmov_b32 s41, 4
    s_cmp_ge_u32 s4, 20
    s_cmov_b32 s41, 320
    s_cmp_ge_u32 s4, 30
    s_cmov_b32 s41, 1073741824
    s_add_u32 s40, s40, s41
    v_lshlrev_b32 v7, 24, v1
    v_add_u32 v7, s40, v7
    s_mov_b32 s38, 0
    s_branch Lpw_18
Lpoll_17:
    buffer_load_dwordx4 v[16:19], v2, s[16:19], s35 offen offset:0 sc1
    buffer_load_dwordx4 v[20:23], v3, s[16:19], s35 offen offset:0 sc1
    s_add_u32 s38, s38, 1
    s_cmp_gt_u32 s38, 100000
    s_cbranch_scc1 L_abort
Lpw_18:
    s_waitcnt vmcnt(0)
    v_max3_u32 v140, v16, v17, v18
    v_max3_u32 v140, v140, v19, v20
    v_max3_u32 v140, v140, v21, v22
    v_max_u32 v140, v140, v23
    v_cmp_eq_u32 vcc, -1, v140
    s_cbranch_vccnz Lpoll_17
    s_waitcnt lgkmcnt(0)
    v_mfma_f32_16x16x32_bf16 v[24:27], v[40:43], v[16:19], 0
    v_mfma_f32_16x16x32_bf16 v[28:31], v[44:47], v[16:19], 0
    v_mfma_f32_16x16x32_bf16 v[32:35], v[48:51], v[16:19], 0
    v_mfma_f32_16x16x32_bf16 v[36:39], v[52:55], v[16:19], 0
    v_mfma_f32_16x16x32_bf16 v[24:27], v[56:59], v[20:23], v[24:27]
    v_mfma_f32_16x16x32_bf16 v[28:31], v[60:63], v[20:23], v[28:31]
    v_mfma_f32_16x16x32_bf16 v[32:35], v[64:67], v[20:23], v[32:35]
    v_mfma_f32_16x16x32_bf16 v[36:39], v[68:71], v[20:23], v[36:39]
    s_nop 5
    v_cndmask_b32 v24, v24, v28, s[52:53]
    v_cndmask_b32 v25, v25, v29, s[52:53]
    v_cndmask_b32 v26, v26, v30, s[52:53]
    v_cndmask_b32 v27, v27, v31, s[52:53]
    ds_write_b128 v4, v[24:27] offset:0
    v_cndmask_b32 v32, v32, v36, s[52:53]
    v_cndmask_b32 v33, v33, v37, s[52:53]
    v_cndmask_b32 v34, v34, v38, s[52:53]
    v_cndmask_b32 v35, v35, v39, s[52:53]
    ds_write_b128 v4, v[32:35] offset:4096
    s_waitcnt lgkmcnt(0)
    s_barrier
    ds_read_b128 v[48:51], v5 offset:0
    ds_read_b128 v[52:55], v5 offset:1024
    ds_read_b128 v[56:59], v5 offset:2048
    ds_read_b128 v[60:63], v5 offset:3072
    s_waitcnt lgkmcnt(2)
    v_pk_add_f32 v[32:33], v[48:49], v[52:53]
    v_pk_add_f32 v[34:35], v[50:51], v[54:55]
    s_waitcnt lgkmcnt(0)
    v_pk_add_f32 v[56:57], v[56:57], v[60:61]
    v_pk_add_f32 v[58:59], v[58:59], v[62:63]
    v_pk_add_f32 v[32:33], v[32:33], v[56:57]
    v_pk_add_f32 v[34:35], v[34:35], v[58:59]
    v_min_u32 v32, -2, v32
    v_min_u32 v33, -2, v33
    v_min_u32 v34, -2, v34
    v_min_u32 v35, -2, v35
    buffer_store_dwordx4 v[32:35], v6, s[16:19], s35 offen sc1
    s_cmp_eq_u32 s37, 1
    s_cbranch_scc1 Lpl_19
    buffer_store_dword v1, v7, s[16:19], s35 offen sc1
    s_branch Lpe_20
Lpl_19:
    buffer_store_dword v1, v7, s[16:19], s35 offen
Lpe_20:
    s_cmp_eq_u32 s36, 1
    s_cbranch_scc1 Lc2_21
    v_mov_b32 v36, -1
    v_mov_b32 v37, -1
    v_mov_b32 v38, -1
    v_mov_b32 v39, -1
    s_mov_b32 s60, 1376256
    buffer_store_dwordx4 v[36:39], v6, s[16:19], s60 offen sc1
Lc2_21:
    s_cmp_ge_u32 s5, 2
    s_cbranch_scc1 Lrg_24
    s_cmp_eq_u32 s36, 1
    s_cbranch_scc1 Lrb_23
    s_mov_b32 s60, 1376256
    v_mov_b32 v56, -1
    v_mov_b32 v57, -1
    v_mov_b32 v58, -1
    v_mov_b32 v59, -1
    v_lshrrev_b32 v41, 4, v1
    v_and_b32 v42, 15, v1
    s_and_b32 s41, s7, 3
    s_lshl_b32 s41, s41, 3
    s_lshr_b32 s40, s7, 2
    s_lshl_b32 s40, s40, 2
    s_add_u32 s41, s41, s40
    s_add_u32 s41, s41, s5
    s_lshl_b32 s40, s6, 5
    s_add_u32 s41, s41, s40
    s_lshl_b32 s40, s41, 9
    v_lshlrev_b32 v40, 6, v42
    v_add_u32 v40, s40, v40
    s_lshl_b32 s40, s41, 6
    s_add_u32 s40, s40, 1310720
    v_cmp_eq_u32 vcc, 8, v42
    v_mov_b32 v42, s40
    s_mov_b32 s42, 0xfe00fe00
    s_mov_b32 s43, 0xfe00fe00
    v_cndmask_b32 v40, v40, v42, vcc
    v_lshl_add_u32 v40, v41, 4, v40
    v_mov_b32 v41, 2147418112
    v_cndmask_b32 v40, v40, v41, s[42:43]
    s_cmp_eq_u32 s37, 1
    s_cbranch_scc1 Lpl_25
    buffer_store_dwordx4 v[56:59], v40, s[16:19], s60 offen sc1
    s_branch Lpe_26
Lpl_25:
    buffer_store_dwordx4 v[56:59], v40, s[16:19], s60 offen
Lpe_26:
    s_lshl_b32 s40, s6, 11
    s_lshl_b32 s41, s7, 8
    s_add_u32 s40, s40, s41
    s_add_u32 s40, s40, s61
    s_add_u32 s40, s40, 524288
    v_lshlrev_b32 v43, 2, v1
    v_add_u32 v43, s40, v43
    s_cmp_eq_u32 s37, 1
    s_cbranch_scc1 Lpl_27
    buffer_store_dword v56, v43, s[16:19], s60 offen sc1
    s_branch Lpe_28
Lpl_27:
    buffer_store_dword v56, v43, s[16:19], s60 offen
Lpe_28:
    s_mul_i32 s40, s3, 640
    s_mul_i32 s41, s78, 32
    s_add_u32 s40, s40, s41
    s_mul_i32 s41, s5, 16
    s_add_u32 s40, s40, s41
    s_add_u32 s40, s40, s1
    s_add_u32 s40, s40, 1277952
    s_mov_b32 s41, 0
    s_cmp_ge_u32 s4, 10
    s_cmov_b32 s41, 4
    s_cmp_ge_u32 s4, 20
    s_cmov_b32 s41, 320
    s_cmp_ge_u32 s4, 30
    s_cmov_b32 s41, 1073741824
    s_add_u32 s40, s40, s41
    v_lshlrev_b32 v44, 24, v1
    v_add_u32 v44, s40, v44
    s_cmp_eq_u32 s37, 1
    s_cbranch_scc1 Lpl_29
    buffer_store_dword v56, v44, s[16:19], s60 offen sc1
    s_branch Lpe_30
Lpl_29:
    buffer_store_dword v56, v44, s[16:19], s60 offen
Lpe_30:
    s_mul_i32 s40, s3, 10240
    s_lshl_b32 s41, s4, 9
    s_add_u32 s40, s40, s41
    s_add_u32 s40, s40, s61
    s_add_u32 s40, s40, 1081344
    v_and_b32 v46, 0x38, v1
    v_and_b32 v41, 7, v1
    v_lshl_add_u32 v46, v41, 6, v46
    v_add_u32 v46, s40, v46
    s_cmp_lt_u32 s4, 20
    s_cselect_b32 s40, 0, 1073741824
    v_add_u32 v46, s40, v46
    s_cmp_eq_u32 s37, 1
    s_cbranch_scc1 Lpl_31
    buffer_store_dwordx2 v[56:57], v46, s[16:19], s60 offen sc1
    s_branch Lpe_32
Lpl_31:
    buffer_store_dwordx2 v[56:57], v46, s[16:19], s60 offen
Lpe_32:
    v_lshrrev_b32 v41, 4, v1
    v_and_b32 v42, 15, v1
    s_sub_u32 s41, s4, 20
    s_cmp_eq_u32 s4, 31
    s_cmov_b32 s41, 12
    s_add_u32 s41, s41, s5
    s_lshl_b32 s40, s3, 12
    s_lshl_b32 s41, s41, 8
    s_add_u32 s40, s40, s41
    s_cmp_ge_u32 s4, 30
    s_cselect_b32 s41, s1, s61
    s_add_u32 s40, s40, s41
    s_add_u32 s40, s40, 1245184
    v_lshlrev_b32 v47, 3, v41
    v_and_b32 v41, 7, v42
    v_lshl_add_u32 v47, v41, 5, v47
    v_lshrrev_b32 v41, 3, v42
    v_lshl_add_u32 v47, v41, 2, v47
    v_add_u32 v47, s40, v47
    s_lshl_b32 s41, s4, 2
    s_add_u32 s41, s41, s5
    s_mov_b32 s44, 0
    s_cmp_eq_u32 s41, 125
    s_cselect_b32 s45, -1, 0
    v_mov_b32 v41, 2147418112
    v_cndmask_b32 v47, v47, v41, s[44:45]
    s_cmp_ge_u32 s4, 20
    s_cselect_b32 s40, 0, 1073741824
    v_or_b32 v47, s40, v47
    s_cmp_eq_u32 s37, 1
    s_cbranch_scc1 Lpl_33
    buffer_store_dword v56, v47, s[16:19], s60 offen sc1
    s_branch Lpe_34
Lpl_33:
    buffer_store_dword v56, v47, s[16:19], s60 offen
Lpe_34:
    v_add_u32 v40, 1024, v40
    s_cmp_eq_u32 s37, 1
    s_cbranch_scc1 Lpl_35
    buffer_store_dwordx4 v[56:59], v40, s[16:19], s60 offen sc1
    s_branch Lpe_36
Lpl_35:
    buffer_store_dwordx4 v[56:59], v40, s[16:19], s60 offen
Lpe_36:
    s_branch Lrb_23
Lrg_24:
    s_mul_i32 s40, s3, 640
    s_mul_i32 s41, s4, 16
    s_add_u32 s40, s40, s41
    s_add_u32 s40, s40, 1277952
    v_lshlrev_b32 v6, 24, v1
    v_add_u32 v6, s40, v6
    buffer_load_dwordx2 v[48:49], v6, s[16:19], s35 offen offset:0 sc1
    v_lshlrev_b32 v2, 3, v1
    ds_read_b64 v[68:69], v2 offset:14592
    s_lshl_b32 s40, s4, 14
    s_and_b32 s41, s5, 1
    s_lshl_b32 s41, s41, 13
    s_add_u32 s40, s40, s41
    s_add_u32 s40, s40, 589824
    v_lshlrev_b32 v4, 4, v1
    v_add_u32 v3, s40, v4
    s_add_u32 s59, s35, 4096
    s_mul_i32 s40, s3, 10240
    s_lshl_b32 s41, s4, 9
    s_add_u32 s40, s40, s41
    s_add_u32 s40, s40, 1081344
    v_and_b32 v5, 0x38, v1
    v_and_b32 v50, 7, v1
    v_lshl_add_u32 v5, v50, 6, v5
    v_add_u32 v5, s40, v5
    s_waitcnt lgkmcnt(0)
    v_lshlrev_b32 v56, 16, v68
    v_and_b32 v57, 0xffff0000, v68
    v_lshlrev_b32 v58, 16, v69
    v_and_b32 v59, 0xffff0000, v69
    s_mov_b32 s38, 0
    s_branch Lpw_38
Lpoll_37:
    buffer_load_dwordx2 v[48:49], v6, s[16:19], s35 offen offset:0 sc1
    s_add_u32 s38, s38, 1
    s_cmp_gt_u32 s38, 100000
    s_cbranch_scc1 L_abort
Lpw_38:
    s_waitcnt vmcnt(0)
    v_max_u32 v52, v48, v49
    v_cmp_eq_u32 vcc, -1, v52
    s_cbranch_vccnz Lpoll_37
    s_mov_b32 s38, 0
Lpoll_39:
    buffer_load_dwordx4 v[16:19], v3, s[16:19], s35 offen offset:0 sc1
    buffer_load_dwordx4 v[20:23], v3, s[16:19], s35 offen offset:1024 sc1
    buffer_load_dwordx4 v[24:27], v3, s[16:19], s35 offen offset:2048 sc1
    buffer_load_dwordx4 v[28:31], v3, s[16:19], s35 offen offset:3072 sc1
    buffer_load_dwordx4 v[32:35], v3, s[16:19], s59 offen offset:0 sc1
    buffer_load_dwordx4 v[36:39], v3, s[16:19], s59 offen offset:1024 sc1
    buffer_load_dwordx4 v[40:43], v3, s[16:19], s59 offen offset:2048 sc1
    buffer_load_dwordx4 v[44:47], v3, s[16:19], s59 offen offset:3072 sc1
    s_add_u32 s38, s38, 1
    s_cmp_gt_u32 s38, 100000
    s_cbranch_scc1 L_abort
Lpw_40:
    s_waitcnt vmcnt(0)
    v_max3_u32 v52, v16, v17, v18
    v_max3_u32 v52, v52, v19, v20
    v_max3_u32 v52, v52, v21, v22
    v_max3_u32 v52, v52, v23, v24
    v_max3_u32 v52, v52, v25, v26
    v_max3_u32 v52, v52, v27, v28
    v_max3_u32 v52, v52, v29, v30
    v_max3_u32 v52, v52, v31, v32
    v_max3_u32 v52, v52, v33, v34
    v_max3_u32 v52, v52, v35, v36
    v_max3_u32 v52, v52, v37, v38
    v_max3_u32 v52, v52, v39, v40
    v_max3_u32 v52, v52, v41, v42
    v_max3_u32 v52, v52, v43, v44
    v_max3_u32 v52, v52, v45, v46
    v_max_u32 v52, v52, v47
    v_cmp_eq_u32 vcc, -1, v52
    s_cbranch_vccnz Lpoll_39
    v_pk_add_f32 v[16:17], v[16:17], v[20:21]
    v_pk_add_f32 v[18:19], v[18:19], v[22:23]
    v_pk_add_f32 v[24:25], v[24:25], v[28:29]
    v_pk_add_f32 v[26:27], v[26:27], v[30:31]
    v_pk_add_f32 v[32:33], v[32:33], v[36:37]
    v_pk_add_f32 v[34:35], v[34:35], v[38:39]
    v_pk_add_f32 v[40:41], v[40:41], v[44:45]
    v_pk_add_f32 v[42:43], v[42:43], v[46:47]
    v_pk_add_f32 v[16:17], v[16:17], v[24:25]
    v_pk_add_f32 v[18:19], v[18:19], v[26:27]
    v_pk_add_f32 v[32:33], v[32:33], v[40:41]
    v_pk_add_f32 v[34:35], v[34:35], v[42:43]
    v_pk_add_f32 v[64:65], v[16:17], v[32:33]
    v_pk_add_f32 v[66:67], v[18:19], v[34:35]
    s_cmp_eq_u32 s5, 2
    s_cbranch_scc1 Lrb_23
    ds_write_b128 v4, v[64:67] offset:10368
    s_waitcnt lgkmcnt(0)
Lrb_23:
    s_waitcnt vmcnt(0)
    s_barrier
    s_cmp_lg_u32 s5, 2
    s_cbranch_scc1 Lrs_22
    ds_read_b128 v[16:19], v4 offset:10368
    s_waitcnt lgkmcnt(0)
    v_pk_add_f32 v[64:65], v[64:65], v[16:17]
    v_pk_add_f32 v[66:67], v[66:67], v[18:19]
    v_pk_add_f32 v[64:65], v[64:65], v[56:57]
    v_pk_add_f32 v[66:67], v[66:67], v[58:59]
    v_cvt_pk_bf16_f32 v68, v64, v65
    v_cvt_pk_bf16_f32 v69, v66, v67
    v_min_u32 v70, -2, v68
    v_min_u32 v71, -2, v69
    s_cmp_eq_u32 s37, 1
    s_cbranch_scc1 Lpl_42
    buffer_store_dwordx2 v[70:71], v5, s[16:19], s35 offen sc1
    s_branch Lpe_43
Lpl_42:
    buffer_store_dwordx2 v[70:71], v5, s[16:19], s35 offen
Lpe_43:
    ds_write_b64 v2, v[68:69] offset:14592
    s_waitcnt lgkmcnt(0)
Lrs_22:
    s_cmp_lg_u32 s5, 2
    s_cbranch_scc1 Lrs_44
    s_mul_i32 s40, s3, 640
    s_mul_i32 s41, s4, 16
    s_add_u32 s40, s40, s41
    s_add_u32 s40, s40, 1278272
    v_lshlrev_b32 v6, 24, v1
    v_add_u32 v6, s40, v6
    buffer_load_dword v48, v6, s[16:19], s35 offen offset:0 sc1
    v_lshlrev_b32 v2, 3, v1
    ds_read_b64 v[68:69], v2 offset:14592
    ds_read_b64 v[70:71], v2 offset:15104
    s_lshl_b32 s40, s4, 13
    s_add_u32 s40, s40, 917504
    v_lshlrev_b32 v4, 4, v1
    v_add_u32 v3, s40, v4
    s_add_u32 s59, s35, 4096
    s_mul_i32 s40, s3, 10240
    s_lshl_b32 s41, s4, 9
    s_add_u32 s40, s40, s41
    s_add_u32 s40, s40, 1163264
    v_and_b32 v5, 0x38, v1
    v_and_b32 v50, 7, v1
    v_lshl_add_u32 v5, v50, 6, v5
    v_add_u32 v5, s40, v5
    s_mov_b32 s28, s84
    s_mov_b32 s29, s85
    s_mov_b32 s30, 10240
    s_mov_b32 s31, 0x20000
    s_mul_i32 s40, s3, 1280
    s_lshl_b32 s41, s4, 6
    s_add_u32 s40, s40, s41
    v_and_b32 v7, 0x38, v1
    v_add_u32 v7, s40, v7
    v_and_b32 v50, 7, v1
    v_mov_b32 v51, 2147418112
    v_cmp_ne_u32 vcc, s3, v50
    s_nop 1
    v_cndmask_b32 v7, v7, v51, vcc
    s_cmp_eq_u32 s36, 1
    s_cbranch_scc1 Lpre_47
    s_mov_b32 s60, 1376256
    v_lshrrev_b32 v50, 4, v1
    v_and_b32 v51, 15, v1
    s_cmp_ge_u32 s4, 10
    s_cselect_b32 s40, 2, 0
    s_lshr_b32 s41, s5, 1
    s_add_u32 s40, s40, s41
    s_mul_i32 s41, s40, 1
    s_add_u32 s41, s41, s3
    s_and_b32 s41, s41, 7
    s_lshl_b32 s40, s40, 3
    s_add_u32 s40, s40, s41
    s_lshl_b32 s40, s40, 11
    s_and_b32 s41, s5, 1
    s_lshl_b32 s41, s41, 7
    s_add_u32 s40, s40, s41
    s_add_u32 s40, s40, 524288
    v_and_b32 v51, 7, v51
    v_lshlrev_b32 v54, 8, v51
    v_lshl_add_u32 v54, v50, 4, v54
    v_add_u32 v54, s40, v54
    buffer_load_dword v55, v54, s[16:19], s60 offen offset:0 sc1
Lpre_47:
    s_waitcnt lgkmcnt(0)
    v_lshlrev_b32 v56, 16, v68
    v_and_b32 v57, 0xffff0000, v68
    v_lshlrev_b32 v58, 16, v69
    v_and_b32 v59, 0xffff0000, v69
    v_lshlrev_b32 v60, 16, v70
    v_and_b32 v61, 0xffff0000, v70
    v_lshlrev_b32 v62, 16, v71
    v_and_b32 v63, 0xffff0000, v71
    v_pk_add_f32 v[56:57], v[56:57], v[60:61]
    v_pk_add_f32 v[58:59], v[58:59], v[62:63]
    s_mov_b32 s38, 0
    s_branch Lpw_46
Lpoll_45:
    buffer_load_dword v48, v6, s[16:19], s35 offen offset:0 sc1
    s_add_u32 s38, s38, 1
    s_cmp_gt_u32 s38, 100000
    s_cbranch_scc1 L_abort
Lpw_46:
    s_waitcnt vmcnt(0)
    v_cmp_eq_u32 vcc, -1, v48
    s_cbranch_vccnz Lpoll_45
    s_mov_b32 s38, 0
Lpoll_48:
    buffer_load_dwordx4 v[16:19], v3, s[16:19], s35 offen offset:0 sc1
    buffer_load_dwordx4 v[20:23], v3, s[16:19], s35 offen offset:1024 sc1
    buffer_load_dwordx4 v[24:27], v3, s[16:19], s35 offen offset:2048 sc1
    buffer_load_dwordx4 v[28:31], v3, s[16:19], s35 offen offset:3072 sc1
    buffer_load_dwordx4 v[32:35], v3, s[16:19], s59 offen offset:0 sc1
    buffer_load_dwordx4 v[36:39], v3, s[16:19], s59 offen offset:1024 sc1
    buffer_load_dwordx4 v[40:43], v3, s[16:19], s59 offen offset:2048 sc1
    buffer_load_dwordx4 v[44:47], v3, s[16:19], s59 offen offset:3072 sc1
    s_add_u32 s38, s38, 1
    s_cmp_gt_u32 s38, 100000
    s_cbranch_scc1 L_abort
Lpw_49:
    s_waitcnt vmcnt(0)
    v_max3_u32 v52, v16, v17, v18
    v_max3_u32 v52, v52, v19, v20
    v_max3_u32 v52, v52, v21, v22
    v_max3_u32 v52, v52, v23, v24
    v_max3_u32 v52, v52, v25, v26
    v_max3_u32 v52, v52, v27, v28
    v_max3_u32 v52, v52, v29, v30
    v_max3_u32 v52, v52, v31, v32
    v_max3_u32 v52, v52, v33, v34
    v_max3_u32 v52, v52, v35, v36
    v_max3_u32 v52, v52, v37, v38
    v_max3_u32 v52, v52, v39, v40
    v_max3_u32 v52, v52, v41, v42
    v_max3_u32 v52, v52, v43, v44
    v_max3_u32 v52, v52, v45, v46
    v_max_u32 v52, v52, v47
    v_cmp_eq_u32 vcc, -1, v52
    s_cbranch_vccnz Lpoll_48
    v_pk_add_f32 v[16:17], v[16:17], v[20:21]
    v_pk_add_f32 v[18:19], v[18:19], v[22:23]
    v_pk_add_f32 v[24:25], v[24:25], v[28:29]
    v_pk_add_f32 v[26:27], v[26:27], v[30:31]
    v_pk_add_f32 v[32:33], v[32:33], v[36:37]
    v_pk_add_f32 v[34:35], v[34:35], v[38:39]
    v_pk_add_f32 v[40:41], v[40:41], v[44:45]
    v_pk_add_f32 v[42:43], v[42:43], v[46:47]
    v_pk_add_f32 v[16:17], v[16:17], v[24:25]
    v_pk_add_f32 v[18:19], v[18:19], v[26:27]
    v_pk_add_f32 v[32:33], v[32:33], v[40:41]
    v_pk_add_f32 v[34:35], v[34:35], v[42:43]
    v_pk_add_f32 v[64:65], v[16:17], v[32:33]
    v_pk_add_f32 v[66:67], v[18:19], v[34:35]
    v_pk_add_f32 v[64:65], v[64:65], v[56:57]
    v_pk_add_f32 v[66:67], v[66:67], v[58:59]
    v_cvt_pk_bf16_f32 v68, v64, v65
    v_cvt_pk_bf16_f32 v69, v66, v67
    s_cmp_eq_u32 s36, 1
    s_cbranch_scc1 Lfinal_50
    v_min_u32 v70, -2, v68
    v_min_u32 v71, -2, v69
    s_cmp_eq_u32 s37, 1
    s_cbranch_scc1 Lpl_51
    buffer_store_dwordx2 v[70:71], v5, s[16:19], s35 offen sc1
    s_branch Lpe_52
Lpl_51:
    buffer_store_dwordx2 v[70:71], v5, s[16:19], s35 offen
Lpe_52:
    ds_write_b64 v2, v[68:69] offset:14592
    s_waitcnt lgkmcnt(0)
    s_branch Lrs_44
Lfinal_50:
    buffer_store_dwordx2 v[68:69], v7, s[28:31], 0 offen
Lrs_44:
    s_branch L_next
L_mlp:
    s_cmp_eq_u32 s36, 1
    s_cbranch_scc1 L_w1go
    s_mov_b32 s20, s76
    s_mov_b32 s21, s77
    s_mov_b32 s22, 2211840
    s_mov_b32 s23, 0x20000
    s_mul_i32 s40, s5, 552960
    s_add_u32 s40, s40, s0
    s_cmp_ge_u32 s4, 30
    s_cbranch_scc1 Lw1lE_53
    v_lshrrev_b32 v16, 1, v1
    v_and_b32 v17, 1, v1
    v_mul_u32_u24 v18, 3456, v16
    v_lshl_add_u32 v18, v17, 4, v18
    s_lshl_b32 s41, s5, 10
    s_add_u32 m0, s34, 32768
    s_nop 0
    buffer_load_dwordx4 v18, s[20:23], s40 offen  lds
    s_add_u32 s40, s40, 110592
    s_add_u32 m0, s34, 33792
    s_nop 0
    buffer_load_dwordx4 v18, s[20:23], s40 offen  lds
    s_add_u32 s40, s40, 110592
    s_add_u32 m0, s34, 34816
    s_nop 0
    buffer_load_dwordx4 v18, s[20:23], s40 offen  lds
    s_add_u32 s40, s40, 110592
    s_add_u32 m0, s34, 35840
    s_nop 0
    buffer_load_dwordx4 v18, s[20:23], s40 offen  lds
    s_add_u32 s40, s40, 110592
    s_add_u32 m0, s41, 131072
    s_nop 0
    buffer_load_dwordx4 v18, s[20:23], s40 offen  lds
    s_add_u32 s40, s40, 110592
    s_branch Lw1lJ_54
Lw1lE_53:
    v_lshrrev_b32 v16, 2, v1
    v_and_b32 v17, 3, v1
    v_mul_u32_u24 v18, 3456, v16
    v_lshl_add_u32 v18, v17, 4, v18
    s_add_u32 m0, s34, 0
    s_nop 0
    buffer_load_dwordx4 v18, s[20:23], s40 offen  lds
    s_add_u32 s40, s40, 55296
    s_add_u32 m0, s34, 1024
    s_nop 0
    buffer_load_dwordx4 v18, s[20:23], s40 offen  lds
    s_add_u32 s40, s40, 55296
    s_add_u32 m0, s34, 2048
    s_nop 0
    buffer_load_dwordx4 v18, s[20:23], s40 offen  lds
    s_add_u32 s40, s40, 55296
    s_add_u32 m0, s34, 3072
    s_nop 0
    buffer_load_dwordx4 v18, s[20:23], s40 offen  lds
    s_add_u32 s40, s40, 55296
    s_add_u32 m0, s34, 4096
    s_nop 0
    buffer_load_dwordx4 v18, s[20:23], s40 offen  lds
    s_add_u32 s40, s40, 55296
    s_add_u32 m0, s34, 5120
    s_nop 0
    buffer_load_dwordx4 v18, s[20:23], s40 offen  lds
    s_add_u32 s40, s40, 55296
    s_add_u32 m0, s34, 6144
    s_nop 0
    buffer_load_dwordx4 v18, s[20:23], s40 offen  lds
    s_add_u32 s40, s40, 55296
    s_add_u32 m0, s34, 7168
    s_nop 0
    buffer_load_dwordx4 v18, s[20:23], s40 offen  lds
    s_add_u32 s40, s40, 55296
    s_add_u32 m0, s34, 32768
    s_nop 0
    buffer_load_dwordx4 v18, s[20:23], s40 offen  lds
    s_add_u32 s40, s40, 55296
    s_add_u32 m0, s34, 33792
    s_nop 0
    buffer_load_dwordx4 v18, s[20:23], s40 offen  lds
    s_add_u32 s40, s40, 55296
Lw1lJ_54:
    s_mov_b32 s60, 1376256
    v_mov_b32 v56, -1
    v_mov_b32 v57, -1
    v_mov_b32 v58, -1
    v_mov_b32 v59, -1
    v_lshrrev_b32 v41, 4, v1
    v_and_b32 v42, 15, v1
    s_and_b32 s41, s7, 3
    s_lshl_b32 s41, s41, 3
    s_lshr_b32 s40, s7, 2
    s_lshl_b32 s40, s40, 2
    s_add_u32 s41, s41, s40
    s_add_u32 s41, s41, s5
    s_lshl_b32 s40, s6, 5
    s_add_u32 s41, s41, s40
    s_lshl_b32 s40, s41, 9
    v_lshlrev_b32 v40, 6, v42
    v_add_u32 v40, s40, v40
    s_lshl_b32 s40, s41, 6
    s_add_u32 s40, s40, 1310720
    v_cmp_eq_u32 vcc, 8, v42
    v_mov_b32 v42, s40
    s_mov_b32 s42, 0xfe00fe00
    s_mov_b32 s43, 0xfe00fe00
    v_cndmask_b32 v40, v40, v42, vcc
    v_lshl_add_u32 v40, v41, 4, v40
    v_mov_b32 v41, 2147418112
    v_cndmask_b32 v40, v40, v41, s[42:43]
    s_cmp_eq_u32 s37, 1
    s_cbranch_scc1 Lpl_55
    buffer_store_dwordx4 v[56:59], v40, s[16:19], s60 offen sc1
    s_branch Lpe_56
Lpl_55:
    buffer_store_dwordx4 v[56:59], v40, s[16:19], s60 offen
Lpe_56:
    s_lshl_b32 s40, s6, 11
    s_lshl_b32 s41, s7, 8
    s_add_u32 s40, s40, s41
    s_add_u32 s40, s40, s61
    s_add_u32 s40, s40, 524288
    v_lshlrev_b32 v43, 2, v1
    v_add_u32 v43, s40, v43
    s_cmp_eq_u32 s37, 1
    s_cbranch_scc1 Lpl_57
    buffer_store_dword v56, v43, s[16:19], s60 offen sc1
    s_branch Lpe_58
Lpl_57:
    buffer_store_dword v56, v43, s[16:19], s60 offen
Lpe_58:
    s_mul_i32 s40, s3, 640
    s_mul_i32 s41, s78, 32
    s_add_u32 s40, s40, s41
    s_mul_i32 s41, s5, 16
    s_add_u32 s40, s40, s41
    s_add_u32 s40, s40, s1
    s_add_u32 s40, s40, 1277952
    s_mov_b32 s41, 0
    s_cmp_ge_u32 s4, 10
    s_cmov_b32 s41, 4
    s_cmp_ge_u32 s4, 20
    s_cmov_b32 s41, 320
    s_cmp_ge_u32 s4, 30
    s_cmov_b32 s41, 1073741824
    s_add_u32 s40, s40, s41
    v_lshlrev_b32 v44, 24, v1
    v_add_u32 v44, s40, v44
    s_cmp_eq_u32 s37, 1
    s_cbranch_scc1 Lpl_59
    buffer_store_dword v56, v44, s[16:19], s60 offen sc1
    s_branch Lpe_60
Lpl_59:
    buffer_store_dword v56, v44, s[16:19], s60 offen
Lpe_60:
    s_mul_i32 s40, s3, 10240
    s_lshl_b32 s41, s4, 9
    s_add_u32 s40, s40, s41
    s_add_u32 s40, s40, s61
    s_add_u32 s40, s40, 1081344
    v_and_b32 v46, 0x38, v1
    v_and_b32 v41, 7, v1
    v_lshl_add_u32 v46, v41, 6, v46
    v_add_u32 v46, s40, v46
    s_cmp_lt_u32 s4, 20
    s_cselect_b32 s40, 0, 1073741824
    v_add_u32 v46, s40, v46
    s_cmp_eq_u32 s37, 1
    s_cbranch_scc1 Lpl_61
    buffer_store_dwordx2 v[56:57], v46, s[16:19], s60 offen sc1
    s_branch Lpe_62
Lpl_61:
    buffer_store_dwordx2 v[56:57], v46, s[16:19], s60 offen
Lpe_62:
    v_lshrrev_b32 v41, 4, v1
    v_and_b32 v42, 15, v1
    s_sub_u32 s41, s4, 20
    s_cmp_eq_u32 s4, 31
    s_cmov_b32 s41, 12
    s_add_u32 s41, s41, s5
    s_lshl_b32 s40, s3, 12
    s_lshl_b32 s41, s41, 8
    s_add_u32 s40, s40, s41
    s_cmp_ge_u32 s4, 30
    s_cselect_b32 s41, s1, s61
    s_add_u32 s40, s40, s41
    s_add_u32 s40, s40, 1245184
    v_lshlrev_b32 v47, 3, v41
    v_and_b32 v41, 7, v42
    v_lshl_add_u32 v47, v41, 5, v47
    v_lshrrev_b32 v41, 3, v42
    v_lshl_add_u32 v47, v41, 2, v47
    v_add_u32 v47, s40, v47
    s_lshl_b32 s41, s4, 2
    s_add_u32 s41, s41, s5
    s_mov_b32 s44, 0
    s_cmp_eq_u32 s41, 125
    s_cselect_b32 s45, -1, 0
    v_mov_b32 v41, 2147418112
    v_cndmask_b32 v47, v47, v41, s[44:45]
    s_cmp_ge_u32 s4, 20
    s_cselect_b32 s40, 0, 1073741824
    v_or_b32 v47, s40, v47
    s_cmp_eq_u32 s37, 1
    s_cbranch_scc1 Lpl_63
    buffer_store_dword v56, v47, s[16:19], s60 offen sc1
    s_branch Lpe_64
Lpl_63:
    buffer_store_dword v56, v47, s[16:19], s60 offen
Lpe_64:
    v_lshrrev_b32 v41, 4, v1
    v_and_b32 v42, 15, v1
    s_cmp_lt_u32 s4, 20
    s_cselect_b32 s41, 14, 13
    s_lshl_b32 s40, s5, s41
    s_add_u32 s40, s40, s79
    s_add_u32 s40, s40, s1
    v_lshlrev_b32 v44, 7, v41
    v_and_b32 v41, 7, v42
    v_lshl_add_u32 v44, v41, 4, v44
    v_lshrrev_b32 v41, 3, v42
    v_lshl_add_u32 v44, v41, 9, v44
    v_add_u32 v44, s40, v44
    buffer_store_dwordx4 v[56:59], v44, s[16:19], s60 offen sc1
L_w1go:
    v_lshrrev_b32 v40, 4, v1
    v_and_b32 v41, 15, v1
    s_lshl_b32 s40, s3, 12
    s_lshl_b32 s41, s5, 10
    s_add_u32 s40, s40, s41
    s_add_u32 s40, s40, 1245184
    v_and_b32 v41, 7, v41
    v_lshlrev_b32 v44, 5, v41
    v_lshrrev_b32 v41, 1, v40
    v_lshl_add_u32 v44, v41, 8, v44
    v_and_b32 v41, 1, v40
    v_lshl_add_u32 v44, v41, 4, v44
    v_add_u32 v44, s40, v44
    v_add_u32 v45, 512, v44
    s_cmp_eq_u32 s5, 3
    s_cselect_b32 s40, 48, 64
    s_cselect_b32 s41, 0, 64
    v_mov_b32 v41, 2147418112
    v_cmp_le_u32 vcc, s40, v1
    v_cmp_le_u32 s[44:45], s41, v1
    s_nop 0
    v_cndmask_b32 v44, v44, v41, vcc
    v_cndmask_b32 v45, v45, v41, s[44:45]
    buffer_load_dword v46, v44, s[16:19], s35 offen offset:0 sc1
    buffer_load_dword v47, v45, s[16:19], s35 offen offset:0 sc1
    v_lshrrev_b32 v40, 4, v1
    v_and_b32 v41, 15, v1
    s_sub_u32 s41, s4, 20
    s_cmp_eq_u32 s4, 31
    s_cmov_b32 s41, 12
    s_add_u32 s41, s41, s5
    s_lshl_b32 s40, s3, 12
    s_lshl_b32 s41, s41, 8
    s_add_u32 s40, s40, s41
    s_cmp_ge_u32 s4, 30
    s_cselect_b32 s41, s1, s61
    s_add_u32 s40, s40, s41
    s_add_u32 s40, s40, 1245184
    v_lshlrev_b32 v6, 3, v40
    v_and_b32 v40, 7, v41
    v_lshl_add_u32 v6, v40, 5, v6
    v_lshrrev_b32 v40, 3, v41
    v_lshl_add_u32 v6, v40, 2, v6
    v_add_u32 v6, s40, v6
    s_lshl_b32 s41, s4, 2
    s_add_u32 s41, s41, s5
    s_mov_b32 s44, 0
    s_cmp_eq_u32 s41, 125
    s_cselect_b32 s45, -1, 0
    v_mov_b32 v40, 2147418112
    v_cndmask_b32 v6, v6, v40, s[44:45]
    s_and_b32 s40, s5, 1
    s_lshl_b32 s40, s40, 8
    v_lshlrev_b32 v40, 2, v1
    v_add_u32 v40, s40, v40
    ds_read_b32 v7, v40 offset:15616
    v_lshrrev_b32 v40, 4, v1
    v_and_b32 v41, 15, v1
    s_mul_i32 s40, s3, 10240
    s_mul_i32 s41, s5, 2560
    s_add_u32 s40, s40, s41
    s_add_u32 s40, s40, 1081344
    v_lshlrev_b32 v2, 6, v41
    v_lshl_add_u32 v2, v40, 4, v2
    v_add_u32 v2, s40, v2
    v_lshlrev_b32 v4, 4, v0
    s_bitcmp1_b32 s5, 0
    s_mov_b32 s40, 10368
    s_cmov_b32 s40, 4096
    v_lshrrev_b32 v42, 3, v41
    v_lshlrev_b32 v3, 3, v42
    v_lshl_add_u32 v3, v40, 8, v3
    v_add_u32 v3, s40, v3
    v_and_b32 v42, 7, v41
    v_lshl_add_u32 v5, v42, 4, v3
    v_add_u32 v3, 128, v3
    s_lshl_b32 s40, s5, 6
    s_add_u32 s40, s40, 8192
    v_lshlrev_b32 v36, 2, v41
    v_add_u32 v36, s40, v36
    v_add_u32 v37, 32, v36
    v_cndmask_b32 v36, v36, v37, s[48:49]
    v_mov_b32 v37, 8704
    s_mov_b32 vcc_lo, 0x00f0000f
    s_mov_b32 vcc_hi, 0x000000ff
    v_cndmask_b32 v36, v37, v36, vcc
    v_lshlrev_b32 v37, 2, v42
    v_add_u32 v37, 8192, v37
    v_cmp_eq_u32 vcc, 8, v41
    v_mov_b32 v38, 0x3f803f80
    s_nop 0
    v_cndmask_b32 v38, 0, v38, vcc
    v_mov_b32 v16, v38
    v_mov_b32 v17, v38
    v_mov_b32 v18, v38
    v_mov_b32 v19, v38
    v_mov_b32 v20, v38
    v_mov_b32 v21, v38
    v_mov_b32 v22, v38
    v_mov_b32 v23, v38
    v_mov_b32 v24, v38
    v_mov_b32 v25, v38
    v_mov_b32 v26, v38
    v_mov_b32 v27, v38
    v_mov_b32 v28, v38
    v_mov_b32 v29, v38
    v_mov_b32 v30, v38
    v_mov_b32 v31, v38
    v_mov_b32 v32, v38
    v_mov_b32 v33, v38
    v_mov_b32 v34, v38
    v_mov_b32 v35, v38
    v_bfe_u32 v42, v1, 2, 2
    v_lshl_add_u32 v42, v40, 3, v42
    v_and_b32 v43, 3, v1
    v_lshlrev_b32 v43, 3, v43
    s_waitcnt vmcnt(0)
    s_cmp_ge_u32 s4, 30
    s_cbranch_scc1 Lw1E0_65
    v_lshl_add_u32 v42, v42, 5, v43
    s_lshl_b32 s40, s5, 10
    s_add_u32 s40, s40, 131072
    v_add_u32 v43, s40, v42
    v_add_u32 v42, s34, v42
    ds_read_b64_tr_b16 v[48:49], v42 offset:32768
    ds_read_b64_tr_b16 v[50:51], v42 offset:32896
    ds_read_b64_tr_b16 v[52:53], v42 offset:33792
    ds_read_b64_tr_b16 v[54:55], v42 offset:33920
    ds_read_b64_tr_b16 v[56:57], v42 offset:34816
    ds_read_b64_tr_b16 v[58:59], v42 offset:34944
    ds_read_b64_tr_b16 v[60:61], v42 offset:35840
    ds_read_b64_tr_b16 v[62:63], v42 offset:35968
    ds_read_b64_tr_b16 v[64:65], v43 offset:0
    ds_read_b64_tr_b16 v[66:67], v43 offset:128
    s_branch Lw1J0_66
Lw1E0_65:
    v_lshl_add_u32 v42, v42, 6, v43
    v_add_u32 v42, s34, v42
    ds_read_b64_tr_b16 v[48:49], v42 offset:0
    ds_read_b64_tr_b16 v[50:51], v42 offset:256
    ds_read_b64_tr_b16 v[52:53], v42 offset:2048
    ds_read_b64_tr_b16 v[54:55], v42 offset:2304
    ds_read_b64_tr_b16 v[56:57], v42 offset:4096
    ds_read_b64_tr_b16 v[58:59], v42 offset:4352
    ds_read_b64_tr_b16 v[60:61], v42 offset:6144
    ds_read_b64_tr_b16 v[62:63], v42 offset:6400
    ds_read_b64_tr_b16 v[64:65], v42 offset:32768
    ds_read_b64_tr_b16 v[66:67], v42 offset:33024
Lw1J0_66:
    s_not_b64 exec, s[52:53]
    s_mov_b32 s38, 0
Lpoll_68:
    buffer_load_dwordx4 v[16:19], v2, s[16:19], s35 offen offset:0 sc1
    buffer_load_dwordx4 v[20:23], v2, s[16:19], s35 offen offset:512 sc1
    buffer_load_dwordx4 v[24:27], v2, s[16:19], s35 offen offset:1024 sc1
    buffer_load_dwordx4 v[28:31], v2, s[16:19], s35 offen offset:1536 sc1
    buffer_load_dwordx4 v[32:35], v2, s[16:19], s35 offen offset:2048 sc1
    s_add_u32 s38, s38, 1
    s_cmp_gt_u32 s38, 100000
    s_cbranch_scc1 L_abort
Lpw_69:
    s_waitcnt vmcnt(0)
    v_max3_u32 v39, v16, v17, v18
    v_max3_u32 v39, v39, v19, v20
    v_max3_u32 v39, v39, v21, v22
    v_max3_u32 v39, v39, v23, v24
    v_max3_u32 v39, v39, v25, v26
    v_max3_u32 v39, v39, v27, v28
    v_max3_u32 v39, v39, v29, v30
    v_max3_u32 v39, v39, v31, v32
    v_max3_u32 v39, v39, v33, v34
    v_max_u32 v39, v39, v35
    v_cmp_eq_u32 vcc, -1, v39
    s_cbranch_vccnz Lpoll_68
    s_mov_b64 exec, -1
    s_waitcnt lgkmcnt(0)
    s_cmp_ge_u32 s4, 30
    s_cbranch_scc1 Lw1E_70
    v_mfma_f32_16x16x32_bf16 v[68:71], v[48:51], v[16:19], 0
    v_mfma_f32_16x16x32_bf16 v[140:143], v[16:19], v[16:19], 0
    v_mfma_f32_16x16x32_bf16 v[68:71], v[52:55], v[20:23], v[68:71]
    v_mfma_f32_16x16x32_bf16 v[140:143], v[20:23], v[20:23], v[140:143]
    v_mfma_f32_16x16x32_bf16 v[68:71], v[56:59], v[24:27], v[68:71]
    v_mfma_f32_16x16x32_bf16 v[140:143], v[24:27], v[24:27], v[140:143]
    v_mfma_f32_16x16x32_bf16 v[68:71], v[60:63], v[28:31], v[68:71]
    v_mfma_f32_16x16x32_bf16 v[140:143], v[28:31], v[28:31], v[140:143]
    v_mfma_f32_16x16x32_bf16 v[68:71], v[64:67], v[32:35], v[68:71]
    v_mfma_f32_16x16x32_bf16 v[140:143], v[32:35], v[32:35], v[140:143]
    s_branch Lw1D_67
Lw1E_70:
    v_mfma_f32_16x16x32_bf16 v[68:71], v[48:51], v[16:19], 0
    v_mfma_f32_16x16x32_bf16 v[140:143], v[16:19], v[16:19], 0
    ds_read_b64_tr_b16 v[48:49], v42 offset:32
    ds_read_b64_tr_b16 v[50:51], v42 offset:288
    v_mfma_f32_16x16x32_bf16 v[68:71], v[52:55], v[20:23], v[68:71]
    v_mfma_f32_16x16x32_bf16 v[140:143], v[20:23], v[20:23], v[140:143]
    ds_read_b64_tr_b16 v[52:53], v42 offset:2080
    ds_read_b64_tr_b16 v[54:55], v42 offset:2336
    v_mfma_f32_16x16x32_bf16 v[68:71], v[56:59], v[24:27], v[68:71]
    v_mfma_f32_16x16x32_bf16 v[140:143], v[24:27], v[24:27], v[140:143]
    ds_read_b64_tr_b16 v[56:57], v42 offset:4128
    ds_read_b64_tr_b16 v[58:59], v42 offset:4384
    v_mfma_f32_16x16x32_bf16 v[68:71], v[60:63], v[28:31], v[68:71]
    v_mfma_f32_16x16x32_bf16 v[140:143], v[28:31], v[28:31], v[140:143]
    ds_read_b64_tr_b16 v[60:61], v42 offset:6176
    ds_read_b64_tr_b16 v[62:63], v42 offset:6432
    v_mfma_f32_16x16x32_bf16 v[68:71], v[64:67], v[32:35], v[68:71]
    v_mfma_f32_16x16x32_bf16 v[140:143], v[32:35], v[32:35], v[140:143]
    ds_read_b64_tr_b16 v[64:65], v42 offset:32800
    ds_read_b64_tr_b16 v[66:67], v42 offset:33056
    s_waitcnt lgkmcnt(8)
    v_mfma_f32_16x16x32_bf16 v[44:47], v[48:51], v[16:19], 0
    s_waitcnt lgkmcnt(6)
    v_mfma_f32_16x16x32_bf16 v[44:47], v[52:55], v[20:23], v[44:47]
    s_waitcnt lgkmcnt(4)
    v_mfma_f32_16x16x32_bf16 v[44:47], v[56:59], v[24:27], v[44:47]
    s_waitcnt lgkmcnt(2)
    v_mfma_f32_16x16x32_bf16 v[44:47], v[60:63], v[28:31], v[44:47]
    s_waitcnt lgkmcnt(0)
    v_mfma_f32_16x16x32_bf16 v[44:47], v[64:67], v[32:35], v[44:47]
    s_nop 7
    ds_write_b128 v4, v[44:47] offset:4096
Lw1D_67:
    s_mov_b32 s44, 0x22222222
    s_mov_b32 s45, 0
    s_mov_b32 s42, 0x44444444
    s_mov_b32 s43, 0
    s_mov_b32 vcc_lo, 0x88888888
    s_mov_b32 vcc_hi, 0
    s_nop 0
    v_cndmask_b32 v140, v140, v141, s[44:45]
    v_cndmask_b32 v142, v142, v143, vcc
    ds_write_b128 v4, v[68:71] offset:10368
    s_or_b64 s[42:43], s[42:43], vcc
    v_cndmask_b32 v140, v140, v142, s[42:43]
    ds_write_b32 v36, v140
    s_waitcnt lgkmcnt(0)
    s_barrier
    ds_read2_b32 v[16:17], v37 offset0:0 offset1:8
    ds_read2_b32 v[18:19], v37 offset0:16 offset1:24
    ds_read2_b32 v[20:21], v37 offset0:32 offset1:40
    ds_read2_b32 v[22:23], v37 offset0:48 offset1:56
    ds_read_b64 v[24:25], v5 offset:0
    ds_read_b64 v[26:27], v5 offset:1024
    ds_read_b64 v[28:29], v5 offset:2048
    ds_read_b64 v[30:31], v5 offset:3072
    ds_read_b64 v[48:49], v3 offset:0
    ds_read_b64 v[50:51], v3 offset:1024
    ds_read_b64 v[52:53], v3 offset:2048
    ds_read_b64 v[54:55], v3 offset:3072
    v_lshlrev_b32 v40, 16, v7
    v_and_b32 v41, 0xffff0000, v7
    s_waitcnt lgkmcnt(8)
    v_pk_add_f32 v[16:17], v[16:17], v[18:19]
    v_pk_add_f32 v[20:21], v[20:21], v[22:23]
    v_pk_add_f32 v[16:17], v[16:17], v[20:21]
    v_mul_f32 v17, 0x3acccccd, v17
    v_mul_f32 v16, 0x3acccccd, v16
    v_fma_f32 v16, -v17, v17, v16
    v_max_f32 v16, 0, v16
    v_add_f32 v18, 0x3727c5ac, v16
    v_rcp_f32 v19, v18
    v_rsq_f32 v18, v18
    s_waitcnt lgkmcnt(4)
    v_pk_add_f32 v[24:25], v[24:25], v[26:27]
    v_mul_f32 v19, v19, v16
    v_add_f32 v19, 0x3727c5ac, v19
    v_rsq_f32 v19, v19
    v_pk_add_f32 v[28:29], v[28:29], v[30:31]
    s_waitcnt lgkmcnt(0)
    v_pk_add_f32 v[48:49], v[48:49], v[50:51]
    v_pk_add_f32 v[52:53], v[52:53], v[54:55]
    v_mul_f32 v18, v18, v19
    v_pk_add_f32 v[24:25], v[24:25], v[28:29]
    v_pk_add_f32 v[48:49], v[48:49], v[52:53]
    v_fma_f32 v24, -v17, v48, v24
    v_fma_f32 v25, -v17, v49, v25
    v_fma_f32 v16, v24, v18, v40
    v_fma_f32 v17, v25, v18, v41
    v_mul_f32 v18, v16, v16
    v_mul_f32 v19, v17, v17
    v_mul_f32 v18, 0x3d372713, v18
    v_mul_f32 v19, 0x3d372713, v19
    v_fma_f32 v18, v18, v16, v16
    v_fma_f32 v19, v19, v17, v17
    v_mul_f32 v18, 0xc0135761, v18
    v_mul_f32 v19, 0xc0135761, v19
    v_exp_f32 v18, v18
    v_exp_f32 v19, v19
    s_nop 0
    v_add_f32 v18, 1.0, v18
    v_add_f32 v19, 1.0, v19
    v_rcp_f32 v18, v18
    v_rcp_f32 v19, v19
    s_nop 0
    v_mul_f32 v16, v16, v18
    v_mul_f32 v17, v17, v19
    v_cvt_pk_bf16_f32 v16, v16, v17
    v_min_u32 v16, -2, v16
    s_cmp_eq_u32 s37, 1
    s_cbranch_scc1 Lpl_71
    buffer_store_dword v16, v6, s[16:19], s35 offen sc1
    s_branch Lpe_72
Lpl_71:
    buffer_store_dword v16, v6, s[16:19], s35 offen
Lpe_72:
    s_cmp_ge_u32 s4, 30
    s_cbranch_scc1 L_mlpend
    v_lshrrev_b32 v16, 4, v1
    v_and_b32 v17, 15, v1
    s_lshl_b32 s40, s3, 12
    s_lshl_b32 s41, s5, 10
    s_add_u32 s40, s40, s41
    s_add_u32 s40, s40, 1245184
    v_and_b32 v17, 7, v17
    v_lshlrev_b32 v2, 5, v17
    v_lshrrev_b32 v17, 1, v16
    v_lshl_add_u32 v2, v17, 8, v2
    v_and_b32 v17, 1, v16
    v_lshl_add_u32 v2, v17, 4, v2
    v_add_u32 v2, s40, v2
    v_add_u32 v3, 512, v2
    s_cmp_eq_u32 s5, 3
    s_cselect_b32 s40, 48, 64
    s_cselect_b32 s41, 0, 64
    v_mov_b32 v17, 2147418112
    v_cmp_le_u32 vcc, s40, v1
    v_cmp_le_u32 s[44:45], s41, v1
    s_nop 0
    v_cndmask_b32 v2, v2, v17, vcc
    v_cndmask_b32 v3, v3, v17, s[44:45]
    buffer_load_dwordx4 v[16:19], v2, s[16:19], s35 offen offset:0 sc1
    buffer_load_dwordx4 v[20:23], v3, s[16:19], s35 offen offset:0 sc1
    v_lshrrev_b32 v25, 4, v1
    v_bfe_u32 v24, v1, 2, 2
    v_lshl_add_u32 v24, v25, 3, v24
    v_lshlrev_b32 v24, 7, v24
    v_and_b32 v25, 3, v1
    v_lshl_add_u32 v24, v25, 3, v24
    v_add_u32 v24, s34, v24
    s_waitcnt vmcnt(2)
    ds_read_b64_tr_b16 v[40:41], v24 offset:0
    ds_read_b64_tr_b16 v[42:43], v24 offset:512
    ds_read_b64_tr_b16 v[44:45], v24 offset:32
    ds_read_b64_tr_b16 v[46:47], v24 offset:544
    ds_read_b64_tr_b16 v[48:49], v24 offset:64
    ds_read_b64_tr_b16 v[50:51], v24 offset:576
    ds_read_b64_tr_b16 v[52:53], v24 offset:96
    ds_read_b64_tr_b16 v[54:55], v24 offset:608
    ds_read_b64_tr_b16 v[56:57], v24 offset:4096
    ds_read_b64_tr_b16 v[58:59], v24 offset:4608
    ds_read_b64_tr_b16 v[60:61], v24 offset:4128
    ds_read_b64_tr_b16 v[62:63], v24 offset:4640
    ds_read_b64_tr_b16 v[64:65], v24 offset:4160
    ds_read_b64_tr_b16 v[66:67], v24 offset:4672
    ds_read_b64_tr_b16 v[68:69], v24 offset:4192
    ds_read_b64_tr_b16 v[70:71], v24 offset:4704
    v_lshlrev_b32 v4, 4, v0
    s_and_b32 s40, s5, 1
    s_lshl_b32 s40, s40, 12
    v_lshlrev_b32 v5, 4, v1
    v_add_u32 v5, s40, v5
    v_lshrrev_b32 v25, 4, v1
    v_and_b32 v26, 15, v1
    s_cmp_lt_u32 s4, 20
    s_cselect_b32 s41, 14, 13
    s_lshl_b32 s40, s5, s41
    s_add_u32 s40, s40, s79
    s_add_u32 s40, s40, s1
    v_lshlrev_b32 v6, 7, v25
    v_and_b32 v25, 7, v26
    v_lshl_add_u32 v6, v25, 4, v6
    v_lshrrev_b32 v25, 3, v26
    v_lshl_add_u32 v6, v25, 9, v6
    v_add_u32 v6, s40, v6
    s_mul_i32 s40, s3, 640
    s_mul_i32 s41, s78, 32
    s_add_u32 s40, s40, s41
    s_mul_i32 s41, s5, 16
    s_add_u32 s40, s40, s41
    s_add_u32 s40, s40, s1
    s_add_u32 s40, s40, 1277952
    s_mov_b32 s41, 0
    s_cmp_ge_u32 s4, 10
    s_cmov_b32 s41, 4
    s_cmp_ge_u32 s4, 20
    s_cmov_b32 s41, 320
    s_cmp_ge_u32 s4, 30
    s_cmov_b32 s41, 1073741824
    s_add_u32 s40, s40, s41
    v_lshlrev_b32 v7, 24, v1
    v_add_u32 v7, s40, v7
    s_mov_b32 s38, 0
    s_branch Lpw_74
Lpoll_73:
    buffer_load_dwordx4 v[16:19], v2, s[16:19], s35 offen offset:0 sc1
    buffer_load_dwordx4 v[20:23], v3, s[16:19], s35 offen offset:0 sc1
    s_add_u32 s38, s38, 1
    s_cmp_gt_u32 s38, 100000
    s_cbranch_scc1 L_abort
Lpw_74:
    s_waitcnt vmcnt(0)
    v_max3_u32 v140, v16, v17, v18
    v_max3_u32 v140, v140, v19, v20
    v_max3_u32 v140, v140, v21, v22
    v_max_u32 v140, v140, v23
    v_cmp_eq_u32 vcc, -1, v140
    s_cbranch_vccnz Lpoll_73
    s_waitcnt lgkmcnt(0)
    v_mfma_f32_16x16x32_bf16 v[24:27], v[40:43], v[16:19], 0
    v_mfma_f32_16x16x32_bf16 v[28:31], v[44:47], v[16:19], 0
    v_mfma_f32_16x16x32_bf16 v[32:35], v[48:51], v[16:19], 0
    v_mfma_f32_16x16x32_bf16 v[36:39], v[52:55], v[16:19], 0
    v_mfma_f32_16x16x32_bf16 v[24:27], v[56:59], v[20:23], v[24:27]
    v_mfma_f32_16x16x32_bf16 v[28:31], v[60:63], v[20:23], v[28:31]
    v_mfma_f32_16x16x32_bf16 v[32:35], v[64:67], v[20:23], v[32:35]
    v_mfma_f32_16x16x32_bf16 v[36:39], v[68:71], v[20:23], v[36:39]
    s_nop 5
    v_cndmask_b32 v24, v24, v28, s[52:53]
    v_cndmask_b32 v25, v25, v29, s[52:53]
    v_cndmask_b32 v26, v26, v30, s[52:53]
    v_cndmask_b32 v27, v27, v31, s[52:53]
    ds_write_b128 v4, v[24:27] offset:0
    v_cndmask_b32 v32, v32, v36, s[52:53]
    v_cndmask_b32 v33, v33, v37, s[52:53]
    v_cndmask_b32 v34, v34, v38, s[52:53]
    v_cndmask_b32 v35, v35, v39, s[52:53]
    ds_write_b128 v4, v[32:35] offset:4096
    s_waitcnt lgkmcnt(0)
    s_barrier
    ds_read_b128 v[48:51], v5 offset:0
    ds_read_b128 v[52:55], v5 offset:1024
    ds_read_b128 v[56:59], v5 offset:2048
    ds_read_b128 v[60:63], v5 offset:3072
    s_waitcnt lgkmcnt(2)
    v_pk_add_f32 v[32:33], v[48:49], v[52:53]
    v_pk_add_f32 v[34:35], v[50:51], v[54:55]
    s_waitcnt lgkmcnt(0)
    v_pk_add_f32 v[56:57], v[56:57], v[60:61]
    v_pk_add_f32 v[58:59], v[58:59], v[62:63]
    v_pk_add_f32 v[32:33], v[32:33], v[56:57]
    v_pk_add_f32 v[34:35], v[34:35], v[58:59]
    v_min_u32 v32, -2, v32
    v_min_u32 v33, -2, v33
    v_min_u32 v34, -2, v34
    v_min_u32 v35, -2, v35
    buffer_store_dwordx4 v[32:35], v6, s[16:19], s35 offen sc1
    s_cmp_eq_u32 s37, 1
    s_cbranch_scc1 Lpl_75
    buffer_store_dword v1, v7, s[16:19], s35 offen sc1
    s_branch Lpe_76
Lpl_75:
    buffer_store_dword v1, v7, s[16:19], s35 offen
Lpe_76:
L_mlpend:
L_next:
    s_cmp_eq_u32 s36, 1
    s_cbranch_scc1 L_fin
    s_mov_b32 s36, 1
    s_mov_b32 s35, 1376256
    v_lshrrev_b32 v40, 4, v1
    v_and_b32 v41, 15, v1
    s_mul_i32 s40, s3, 10240
    s_and_b32 s41, s7, 3
    s_mul_i32 s41, s41, 2560
    s_add_u32 s41, s41, s40
    v_and_b32 v41, 7, v41
    v_lshlrev_b32 v42, 6, v41
    v_lshl_add_u32 v42, v40, 4, v42
    v_add_u32 v42, s41, v42
    v_mov_b32 v40, 2147418112
    v_cndmask_b32 v42, v42, v40, s[52:53]
    s_add_u32 s58, s35, -212992
    buffer_load_dwordx4 v[16:19], v42, s[16:19], s58 offen offset:0 sc1
    buffer_load_dwordx4 v[20:23], v42, s[16:19], s58 offen offset:512 sc1
    buffer_load_dwordx4 v[24:27], v42, s[16:19], s58 offen offset:1024 sc1
    buffer_load_dwordx4 v[28:31], v42, s[16:19], s58 offen offset:1536 sc1
    buffer_load_dwordx4 v[32:35], v42, s[16:19], s58 offen offset:2048 sc1
    v_lshrrev_b32 v40, 4, v1
    v_and_b32 v41, 15, v1
    s_and_b32 s41, s7, 3
    s_lshl_b32 s41, s41, 3
    s_lshr_b32 s40, s7, 2
    s_lshl_b32 s40, s40, 2
    s_add_u32 s41, s41, s40
    s_add_u32 s41, s41, s5
    s_lshl_b32 s40, s6, 5
    s_add_u32 s41, s41, s40
    s_lshl_b32 s40, s41, 9
    v_lshlrev_b32 v45, 6, v41
    v_add_u32 v45, s40, v45
    v_lshl_add_u32 v45, v40, 4, v45
    v_mov_b32 v40, 2147418112
    v_cndmask_b32 v45, v45, v40, s[52:53]
    s_mul_i32 s40, s3, 10240
    s_lshl_b32 s41, s7, 6
    s_add_u32 s40, s40, s41
    v_lshrrev_b32 v41, 2, v1
    v_lshlrev_b32 v46, 9, v41
    v_and_b32 v41, 3, v1
    v_lshl_add_u32 v46, v41, 4, v46
    v_add_u32 v46, s40, v46
    v_add_u32 v47, 8192, v46
    v_cmp_le_u32 vcc, 16, v1
    v_mov_b32 v40, 2147418112
    s_nop 0
    v_cndmask_b32 v47, v47, v40, vcc
    s_lshl_b32 s40, s6, 14
    s_lshl_b32 s41, s7, 6
    s_add_u32 s40, s40, s41
    v_lshrrev_b32 v41, 3, v1
    v_lshlrev_b32 v41, 9, v41
    v_add_u32 v41, s40, v41
    v_and_b32 v43, 7, v1
    v_lshl_add_u32 v41, v43, 3, v41
    s_add_u32 s82, s35, 0
    s_add_u32 s83, s35, 4096
    s_add_u32 s86, s35, 8192
    s_add_u32 s87, s35, 12288
    s_lshl_b32 s40, s5, 8
    s_add_u32 s40, s40, s4
    s_sub_u32 s40, s40, 512
    s_cmp_lt_u32 s40, 20
    s_cbranch_scc1 Lpre_79
    buffer_load_dwordx2 v[48:49], v41, s[16:19], s82 offen offset:0 sc1
    buffer_load_dwordx2 v[50:51], v41, s[16:19], s83 offen offset:0 sc1
    buffer_load_dwordx2 v[52:53], v41, s[16:19], s86 offen offset:0 sc1
    buffer_load_dwordx2 v[54:55], v41, s[16:19], s87 offen offset:0 sc1
    v_lshrrev_b32 v57, 4, v1
    v_and_b32 v58, 15, v1
    s_cmp_ge_u32 s4, 10
    s_cselect_b32 s40, 2, 0
    s_lshr_b32 s41, s5, 1
    s_add_u32 s40, s40, s41
    s_mul_i32 s41, s40, 1
    s_add_u32 s41, s41, s3
    s_and_b32 s41, s41, 7
    s_lshl_b32 s40, s40, 3
    s_add_u32 s40, s40, s41
    s_lshl_b32 s40, s40, 11
    s_and_b32 s41, s5, 1
    s_lshl_b32 s41, s41, 7
    s_add_u32 s40, s40, s41
    s_add_u32 s40, s40, 524288
    v_and_b32 v58, 7, v58
    v_lshlrev_b32 v56, 8, v58
    v_lshl_add_u32 v56, v57, 4, v56
    v_add_u32 v56, s40, v56
    buffer_load_dword v59, v56, s[16:19], s35 offen offset:0 sc1
Lpre_79:
    s_mov_b32 s38, 0
    s_branch Lpw_78
Lpoll_77:
    buffer_load_dwordx4 v[16:19], v42, s[16:19], s58 offen offset:0 sc1
    buffer_load_dwordx4 v[20:23], v42, s[16:19], s58 offen offset:512 sc1
    buffer_load_dwordx4 v[24:27], v42, s[16:19], s58 offen offset:1024 sc1
    buffer_load_dwordx4 v[28:31], v42, s[16:19], s58 offen offset:1536 sc1
    buffer_load_dwordx4 v[32:35], v42, s[16:19], s58 offen offset:2048 sc1
    s_add_u32 s38, s38, 1
    s_cmp_gt_u32 s38, 100000
    s_cbranch_scc1 L_abort
Lpw_78:
    s_waitcnt vmcnt(0)
    v_max3_u32 v39, v16, v17, v18
    v_max3_u32 v39, v39, v19, v20
    v_max3_u32 v39, v39, v21, v22
    v_max3_u32 v39, v39, v23, v24
    v_max3_u32 v39, v39, v25, v26
    v_max3_u32 v39, v39, v27, v28
    v_max3_u32 v39, v39, v29, v30
    v_max3_u32 v39, v39, v31, v32
    v_max3_u32 v39, v39, v33, v34
    v_max_u32 v39, v39, v35
    v_cmp_eq_u32 vcc, -1, v39
    s_cbranch_vccnz Lpoll_77
    v_mfma_f32_16x16x32_bf16 v[68:71], v[72:75], v[16:19], 0
    v_mfma_f32_16x16x32_bf16 v[68:71], v[76:79], v[20:23], v[68:71]
    v_mfma_f32_16x16x32_bf16 v[68:71], v[80:83], v[24:27], v[68:71]
    v_mfma_f32_16x16x32_bf16 v[68:71], v[84:87], v[28:31], v[68:71]
    v_mfma_f32_16x16x32_bf16 v[68:71], v[88:91], v[32:35], v[68:71]
    s_nop 7
    v_min_u32 v68, -2, v68
    v_min_u32 v69, -2, v69
    v_min_u32 v70, -2, v70
    v_min_u32 v71, -2, v71
    s_cmp_eq_u32 s37, 1
    s_cbranch_scc1 Lpl_80
    buffer_store_dwordx4 v[68:71], v45, s[16:19], s35 offen sc1
    s_branch Lpe_81
Lpl_80:
    buffer_store_dwordx4 v[68:71], v45, s[16:19], s35 offen
Lpe_81:
    s_branch L_qpoll
L_abort:
L_fin:
    s_waitcnt vmcnt(0)
L_end:
s_endpgm
.section .rodata,"a"
.p2align 6
.amdhsa_kernel interleave_layers__sliding_block_cached__mixer_channel_mlp__decode_kernel
  .amdhsa_next_free_vgpr 512
  .amdhsa_next_free_sgpr 102
  .amdhsa_accum_offset 256
  .amdhsa_group_segment_fixed_size 0
  .amdhsa_kernarg_size 104
  .amdhsa_user_sgpr_count 2
  .amdhsa_user_sgpr_kernarg_segment_ptr 1
  .amdhsa_system_sgpr_workgroup_id_x 1
.end_amdhsa_kernel
```
